```python
import torch

def _softmax(x, axis=-1):
    return torch.softmax(x, dim=axis)
def _gelu(x):
    return torch.nn.functional.gelu(x, approximate="tanh")
def _silu(x):
    return torch.nn.functional.silu(x)
def _sigmoid(x):
    return torch.sigmoid(x)
def _layernorm(x, axis=-1, eps=1e-5):
    m = x.mean(dim=axis, keepdim=True)
    v = x.var(dim=axis, keepdim=True, unbiased=False)
    return (x - m) / torch.sqrt(v + eps)
def _scatter_add(tgt, idx, src, axis=0):
    return tgt.clone().index_add_(axis, idx, src)
def _segment_sum(src, seg, n):
    out = torch.zeros((n,) + src.shape[1:], dtype=src.dtype)
    return out.index_add_(0, seg, src)
def _pad(x, pw):
    flat = tuple(v for pair in reversed(pw) for v in pair)
    return torch.nn.functional.pad(x, flat)

kernel_name = 'standalone__mixer_s_mlp__prompt'

def setup_inputs():

    _w = (lambda a: (lambda t: t.to(torch.bfloat16) if t.is_floating_point() else t)(torch.as_tensor(a)))
    B, S, D, F = 1, 2048, 512, 1376
    return {
        "x":  _w((lambda *s: torch.randn(*s, dtype=torch.bfloat16) * 0.4)(B, S, D)),
        "w1": _w((lambda *s: torch.randn(*s, dtype=torch.bfloat16) * 3.2)(D, D) * (D ** -0.5)),
        "w2": _w((lambda *s: torch.randn(*s, dtype=torch.bfloat16) * 3.2)(D, D) * (D ** -0.5)),
        "w3": _w((lambda *s: torch.randn(*s, dtype=torch.bfloat16) * 3.2)(D, F) * (D ** -0.5)),
        "w4": _w((lambda *s: torch.randn(*s, dtype=torch.bfloat16) * 0.8)(F, D) * (F ** -0.5)),
    }

def reference(x, w1, w2, w3, w4):
    B, S, D = x.shape
    h = _gelu(_layernorm(x, axis=-1) @ w1)
    c = D // 4
    g0 = _pad(h[:, :, 0*c:1*c], ((0, 0), (1, 0), (0, 0)))[:, :S, :]
    g1 = _pad(h[:, :, 1*c:2*c], ((0, 0), (0, 1), (0, 0)))[:, 1:, :]
    g2 = _pad(h[:, :, 2*c:3*c], ((0, 0), (2, 0), (0, 0)))[:, :S, :]
    g3 = _pad(h[:, :, 3*c:   ], ((0, 0), (0, 2), (0, 0)))[:, 2:, :]
    hs = torch.concatenate([g0, g1, g2, g3], axis=-1) @ w2
    x1 = x + hs
    h2 = _gelu(_layernorm(x1, axis=-1) @ w3) @ w4
    return x1 + h2
```

```asm
; @launch grid=(256,1,1) block=(512,1,1) lds=163840
.amdgcn_target "amdgcn-amd-amdhsa--gfx950"
.set CODE_SECTORS_PER_WAVE, 2
.text
.globl standalone__mixer_s_mlp__prompt_kernel
.p2align 8
.type standalone__mixer_s_mlp__prompt_kernel,@function
standalone__mixer_s_mlp__prompt_kernel:
    s_cmp_ge_u32 s2, 256
    s_cbranch_scc1 L_end
    s_load_dwordx16 s[36:51], s[0:1], 0
    v_lshrrev_b32 v4, 6, v0
    v_and_b32 v0, 63, v0
    s_and_b32 s52, s2, 7
    v_readfirstlane_b32 s3, v4
    s_lshr_b32 s60, s2, 6
    s_lshl_b32 s60, s60, 3
    s_or_b32 s52, s52, s60
    s_lshr_b32 s53, s2, 3
    s_and_b32 s53, s53, 7
    v_lshlrev_b32 v1, 4, v0
    s_and_b32 s54, s3, 3
    s_lshr_b32 s55, s54, 1
    s_and_b32 s56, s54, 1
    s_and_b32 s57, s52, 7
    s_lshl_b32 s57, s57, 1
    s_lshl_b32 s88, s54, 10
    s_lshl_b32 s73, s57, 15
    s_getpc_b64 s[100:101]
L_pcC:
    s_sub_u32 s100, s100, L_pcC-standalone__mixer_s_mlp__prompt_kernel
    s_subb_u32 s101, s101, 0
    s_lshr_b32 s60, s2, 6
    s_lshl_b32 s60, s60, 3
    s_add_u32 s60, s60, s53
    s_lshl_b32 s60, s60, 3
    s_add_u32 s60, s60, s3
    s_mul_i32 s60, s60, CODE_SECTORS_PER_WAVE*64
    v_lshlrev_b32 v4, 6, v0
    v_add_u32 v4, s60, v4
    s_mov_b32 s61, L_code_end-standalone__mixer_s_mlp__prompt_kernel-4
    v_min_u32 v4, s61, v4
    s_bfm_b64 exec, CODE_SECTORS_PER_WAVE, 0
    global_load_dword v3, v4, s[100:101]
    s_mov_b64 exec, -1
    s_cmp_lt_u32 s3, 4
    s_cbranch_scc1 L_groupA
    s_lshr_b32 s60, s53, 1
    s_lshr_b32 s61, s60, 1
    s_add_u32 s61, s61, 1
    s_sub_u32 s62, 0, s61
    s_and_b32 s60, s60, 1
    s_cmp_eq_u32 s60, 1
    s_cselect_b32 s60, s61, s62
    s_lshl_b32 s61, s52, 6
    s_add_u32 s60, s60, s61
    s_lshl_b32 s61, s54, 4
    s_add_u32 s60, s60, s61
    v_lshrrev_b32 v4, 4, v0
    v_and_b32 v5, 15, v0
    s_and_b32 s61, s57, 3
    s_lshl_b32 s61, s61, 2
    v_xor_b32 v5, s61, v5
    v_add_u32 v6, 0, v4
    v_xor_b32 v7, v6, v5
    v_add_u32 v6, s60, v6
    v_lshlrev_b32 v6, 10, v6
    v_lshl_add_u32 v216, v7, 4, v6
    v_add_u32 v6, 4, v4
    v_xor_b32 v7, v6, v5
    v_add_u32 v6, s60, v6
    v_lshlrev_b32 v6, 10, v6
    v_lshl_add_u32 v217, v7, 4, v6
    v_add_u32 v6, 8, v4
    v_xor_b32 v7, v6, v5
    v_add_u32 v6, s60, v6
    v_lshlrev_b32 v6, 10, v6
    v_lshl_add_u32 v218, v7, 4, v6
    v_add_u32 v6, 12, v4
    v_xor_b32 v7, v6, v5
    v_add_u32 v6, s60, v6
    v_lshlrev_b32 v6, 10, v6
    v_lshl_add_u32 v219, v7, 4, v6
    s_lshr_b32 s78, s57, 2
    s_lshl_b32 s78, s78, 8
    s_lshl_b32 s72, s54, 12
    s_add_u32 s72, s72, 65536
    v_lshrrev_b32 v4, 3, v0
    v_lshrrev_b32 v5, 1, v4
    v_and_b32 v5, 1, v5
    s_lshl_b32 s60, s56, 1
    v_or_b32 v5, s60, v5
    v_bfe_u32 v6, v0, 1, 2
    v_xor_b32 v5, v5, v6
    v_lshlrev_b32 v5, 5, v5
    v_and_b32 v6, 1, v0
    v_lshl_add_u32 v5, v6, 4, v5
    v_lshl_add_u32 v5, v4, 10, v5
    s_lshl_b32 s60, s54, 13
    s_lshl_b32 s61, s53, 7
    s_add_u32 s60, s60, s61
    v_add_u32 v220, s60, v5
    s_waitcnt lgkmcnt(0)
    s_mov_b32 s4, s36
    s_and_b32 s5, s37, 0xffff
    s_mov_b32 s6, 2097152
    s_mov_b32 s7, 0x20000
    s_mov_b32 s8, s38
    s_and_b32 s9, s39, 0xffff
    s_mov_b32 s10, 524288
    s_mov_b32 s11, 0x20000
    s_add_u32 m0, s72, 0
    s_xor_b32 s84, s78, 0
    buffer_load_dwordx4 v216, s[4:7], s84 offen lds
    s_add_u32 m0, s72, 1024
    s_xor_b32 s84, s78, 0
    buffer_load_dwordx4 v217, s[4:7], s84 offen lds
    s_add_u32 m0, s72, 2048
    s_xor_b32 s84, s78, 0
    buffer_load_dwordx4 v218, s[4:7], s84 offen lds
    s_add_u32 m0, s72, 3072
    s_xor_b32 s84, s78, 0
    buffer_load_dwordx4 v219, s[4:7], s84 offen lds
    s_add_u32 m0, s88, 0
    s_xor_b32 s84, s73, 0
    buffer_load_dwordx4 v220, s[8:11], s84 offen lds
    s_add_u32 m0, s88, 4096
    s_xor_b32 s84, s73, 32768
    buffer_load_dwordx4 v220, s[8:11], s84 offen lds
    s_add_u32 m0, s88, 8192
    s_xor_b32 s84, s73, 65536
    buffer_load_dwordx4 v220, s[8:11], s84 offen lds
    s_add_u32 m0, s88, 12288
    s_xor_b32 s84, s73, 98304
    buffer_load_dwordx4 v220, s[8:11], s84 offen lds
    s_getreg_b32 s83, hwreg(HW_REG_XCC_ID, 0, 4)
    s_add_u32 s60, s53, s52
    s_and_b32 s60, s60, 7
    s_lshl_b32 s58, s60, 1
    s_lshr_b32 s60, s52, 3
    s_mul_i32 s60, s60, 5
    s_lshl_b32 s61, s53, 1
    s_add_u32 s60, s60, s61
    s_cmp_ge_u32 s60, 21
    s_cselect_b32 s61, 21, 0
    s_sub_u32 s0, s60, s61
    s_lshl_b32 s74, s58, 15
    s_lshl_b32 s75, s58, 12
    s_lshl_b32 s76, s52, 9
    s_mul_i32 s89, s54, 3072
    s_add_u32 s89, s89, 65536
    s_lshl_b32 s80, s54, 14
    s_add_u32 s80, s80, 0
    s_sub_u32 s1, 22, s55
    s_mul_i32 s81, s55, 720896
    s_mul_i32 s82, s55, 90112
    s_mul_i32 s79, s52, 176128
    s_add_u32 s79, s79, 5242880
    s_lshl_b32 s99, s52, 16
    s_add_u32 s99, s99, 1048576
    s_mov_b32 s16, s42
    s_and_b32 s17, s43, 0xffff
    s_mov_b32 s18, 1409024
    s_mov_b32 s19, 0x20000
    s_mov_b32 s20, s44
    s_and_b32 s21, s45, 0xffff
    s_mov_b32 s22, 1409024
    s_mov_b32 s23, 0x20000
    s_mov_b32 s12, s40
    s_and_b32 s13, s41, 0xffff
    s_mov_b32 s14, 524288
    s_mov_b32 s15, 0x20000
    v_lshrrev_b32 v4, 4, v0
    v_and_b32 v4, 1, v4
    s_lshl_b32 s60, s52, 6
    s_lshl_b32 s61, s53, 3
    s_add_u32 s60, s60, s61
    s_lshl_b32 s61, s54, 1
    s_add_u32 s60, s60, s61
    v_add_u32 v4, s60, v4
    v_lshlrev_b32 v4, 10, v4
    v_and_b32 v5, 15, v0
    v_lshl_add_u32 v240, v5, 6, v4
    s_lshr_b32 s60, s53, 1
    s_lshr_b32 s61, s60, 1
    s_add_u32 s61, s61, 1
    s_sub_u32 s61, 0, s61
    s_and_b32 s60, s60, 1
    s_cmp_eq_u32 s60, 1
    s_cselect_b32 s60, 64, s61
    s_lshl_b32 s61, s52, 6
    s_add_u32 s60, s60, s61
    v_lshrrev_b32 v4, 4, v0
    v_and_b32 v4, 1, v4
    v_add_u32 v4, s60, v4
    v_lshlrev_b32 v4, 10, v4
    v_lshl_add_u32 v4, v5, 6, v4
    v_cmp_gt_u32 vcc, 32, v0
    s_nop 1
    v_cndmask_b32 v240, v4, v240, vcc
    s_lshr_b32 s60, s52, 3
    s_lshl_b32 s60, s60, 3
    s_add_u32 s3, s60, s53
    s_lshl_b32 s60, s3, 8
    s_lshl_b32 s61, s54, 6
    s_add_u32 s60, s60, s61
    v_add_u32 v4, s60, v0
    v_lshlrev_b32 v241, 6, v4
    s_mul_i32 s60, s2, 86
    s_mul_i32 s61, s56, 43
    s_add_u32 s60, s60, s61
    v_add_u32 v4, s60, v0
    v_lshlrev_b32 v242, 6, v4
    s_lshl_b32 s60, s3, 4
    v_lshrrev_b32 v4, 1, v0
    v_add_u32 v4, s60, v4
    v_lshlrev_b32 v4, 10, v4
    v_and_b32 v5, 1, v0
    v_lshl_add_u32 v4, v5, 6, v4
    s_cmp_lt_u32 s54, 2
    s_cselect_b32 s60, 0, 2130706432
    s_add_u32 s60, s60, 384
    v_add_u32 v245, s60, v4
    s_add_u32 m0, s72, 16384
    s_xor_b32 s84, s78, 256
    buffer_load_dwordx4 v216, s[4:7], s84 offen lds
    s_add_u32 m0, s72, 17408
    s_xor_b32 s84, s78, 256
    buffer_load_dwordx4 v217, s[4:7], s84 offen lds
    s_add_u32 m0, s72, 18432
    s_xor_b32 s84, s78, 256
    buffer_load_dwordx4 v218, s[4:7], s84 offen lds
    s_waitcnt vmcnt(10)
    s_add_u32 m0, s72, 19456
    s_xor_b32 s84, s78, 256
    buffer_load_dwordx4 v219, s[4:7], s84 offen lds
    s_mov_b32 s32, s50
    s_and_b32 s33, s51, 0xffff
    s_mov_b32 s34, 11534336
    s_mov_b32 s35, 0x20000
    s_mov_b32 s24, s46
    s_and_b32 s25, s47, 0xffff
    s_mov_b32 s26, 2097152
    s_mov_b32 s27, 0x20000
    s_mov_b32 s28, s48
    s_and_b32 s29, s49, 0xffff
    s_mov_b32 s30, 256
    s_mov_b32 s31, 0x20000
    s_mov_b32 s36, s58
    s_lshl_b32 s37, s36, 12
    v_lshrrev_b32 v4, 3, v0
    v_lshrrev_b32 v5, 1, v4
    v_and_b32 v5, 3, v5
    v_bfe_u32 v6, v0, 1, 2
    v_xor_b32 v5, v5, v6
    v_lshlrev_b32 v5, 5, v5
    v_and_b32 v6, 1, v0
    v_lshl_add_u32 v5, v6, 4, v5
    v_lshl_add_u32 v5, v4, 10, v5
    s_lshl_b32 s60, s54, 13
    s_lshl_b32 s61, s53, 7
    s_add_u32 s60, s60, s61
    v_add_u32 v221, s60, v5
    v_and_b32 v4, 15, v0
    v_lshrrev_b32 v5, 4, v0
    s_lshl_b32 s60, s52, 6
    s_lshl_b32 s61, s55, 5
    s_add_u32 s60, s60, s61
    v_add_u32 v4, s60, v4
    v_lshlrev_b32 v4, 10, v4
    v_lshl_add_u32 v4, v5, 3, v4
    s_lshl_b32 s60, s53, 7
    s_lshl_b32 s61, s56, 6
    s_add_u32 s60, s60, s61
    v_add_u32 v2, s60, v4
    s_mul_i32 s60, s3, 344
    s_mul_i32 s61, s54, 86
    s_add_u32 s60, s60, s61
    v_add_u32 v4, s60, v0
    v_lshlrev_b32 v246, 7, v4
    v_mov_b32 v228, 0x3f803f80
    v_mov_b32 v229, 0x3f803f80
    v_mov_b32 v230, 0x3f803f80
    v_mov_b32 v231, 0x3f803f80
    s_mov_b32 s64, 0x100001
    s_mov_b32 s65, 0x10000100
    s_mov_b32 s66, 0x200002
    s_mov_b32 s67, 0x20000200
    s_mov_b32 s68, 0x400004
    s_mov_b32 s69, 0x40000400
    s_mov_b32 s70, 0x800008
    s_mov_b32 s71, 0x80000800
    v_and_b32 v232, 31, v0
    v_lshlrev_b32 v232, 2, v232
    s_lshl_b32 s60, s53, 2
    s_add_u32 s60, s60, s54
    s_lshl_b32 s60, s60, 2
    s_add_u32 s60, s60, s76
    v_mov_b32 v234, 2130706432
    v_mov_b32 v6, s60
    v_cmp_eq_u32 vcc, 0, v0
    s_nop 1
    v_cndmask_b32 v234, v234, v6, vcc
    v_mov_b32 v235, 1
    s_mul_i32 s60, s53, 12
    s_mul_i32 s61, s53, 10
    s_add_u32 s61, s61, 6
    s_cmp_ge_u32 s53, 3
    s_cselect_b32 s60, s61, s60
    s_cselect_b32 s62, 1, 0
    s_lshr_b32 s61, s60, 1
    s_mul_i32 s63, s54, 3
    s_add_u32 s91, s63, 1
    s_lshr_b32 s91, s91, 1
    s_cmp_eq_u32 s54, 3
    s_cselect_b32 s93, s62, 0
    s_sub_u32 s91, s91, s93
    s_add_u32 s91, s91, s61
    s_mul_i32 s92, s55, 3
    s_add_u32 s92, s92, 1
    s_add_u32 s92, s92, s61
    s_lshl_b32 s93, s93, 1
    s_sub_u32 s63, s63, s93
    s_add_u32 s60, s60, s63
    s_lshl_b32 s60, s60, 5
    s_and_b32 s62, s62, s55
    s_xor_b32 s93, s62, 1
    v_add_u32 v4, 0, v0
    v_mul_u32_u24 v5, 0xaaab, v4
    v_lshrrev_b32 v5, 18, v5
    v_mul_u32_u24 v6, 6, v5
    v_sub_u32 v6, v4, v6
    v_mul_u32_u24 v5, 2752, v5
    v_lshl_add_u32 v5, v6, 4, v5
    v_add_u32 v225, s60, v5
    s_lshl_b32 s61, s56, 2
    s_sub_u32 s61, 4, s61
    v_subrev_u32 v6, s61, v6
    v_cmp_gt_u32 vcc, 2, v6
    s_cmp_eq_u32 s93, 0
    s_cselect_b64 s[86:87], vcc, 0
    v_mov_b32 v7, 2130706432
    v_cndmask_b32 v225, v225, v7, s[86:87]
    v_add_u32 v4, 64, v0
    v_mul_u32_u24 v5, 0xaaab, v4
    v_lshrrev_b32 v5, 18, v5
    v_mul_u32_u24 v6, 6, v5
    v_sub_u32 v6, v4, v6
    v_mul_u32_u24 v5, 2752, v5
    v_lshl_add_u32 v5, v6, 4, v5
    v_add_u32 v226, s60, v5
    s_lshl_b32 s61, s56, 2
    s_sub_u32 s61, 4, s61
    v_subrev_u32 v6, s61, v6
    v_cmp_gt_u32 vcc, 2, v6
    s_cmp_eq_u32 s93, 0
    s_cselect_b64 s[86:87], vcc, 0
    v_mov_b32 v7, 2130706432
    v_cndmask_b32 v226, v226, v7, s[86:87]
    v_add_u32 v4, 128, v0
    v_mul_u32_u24 v5, 0xaaab, v4
    v_lshrrev_b32 v5, 18, v5
    v_mul_u32_u24 v6, 6, v5
    v_sub_u32 v6, v4, v6
    v_mul_u32_u24 v5, 2752, v5
    v_lshl_add_u32 v5, v6, 4, v5
    v_add_u32 v227, s60, v5
    s_lshl_b32 s61, s56, 2
    s_sub_u32 s61, 4, s61
    v_subrev_u32 v6, s61, v6
    v_cmp_gt_u32 vcc, 2, v6
    s_cmp_eq_u32 s93, 0
    s_cselect_b64 s[86:87], vcc, 0
    v_mov_b32 v7, 2130706432
    v_cndmask_b32 v227, v227, v7, s[86:87]
    v_lshrrev_b32 v4, 2, v0
    v_bfe_u32 v5, v0, 1, 1
    v_bfe_u32 v6, v0, 4, 1
    v_xor_b32 v5, v5, v6
    v_lshlrev_b32 v5, 5, v5
    v_and_b32 v6, 1, v0
    v_lshl_add_u32 v5, v6, 4, v5
    v_lshl_add_u32 v4, v4, 10, v5
    s_lshl_b32 s60, s53, 7
    s_lshl_b32 s61, s56, 6
    s_add_u32 s60, s60, s61
    v_add_u32 v248, s60, v4
    s_lshl_b32 s90, s52, 16
    s_lshl_b32 s60, s53, 1
    s_add_u32 s60, s60, s56
    s_lshl_b32 s60, s60, 12
    s_add_u32 s90, s90, s60
    s_lshl_b32 s61, s55, 11
    s_add_u32 s90, s90, s61
    s_lshl_b32 s60, s52, 16
    s_add_u32 s60, s60, s88
    s_add_u32 s60, s60, 3145728
    v_add_u32 v224, s60, v1
    v_bfe_u32 v4, v0, 2, 2
    v_lshrrev_b32 v5, 4, v0
    v_and_b32 v6, 3, v0
    v_lshrrev_b32 v7, 1, v4
    v_lshl_add_u32 v7, v5, 1, v7
    v_and_b32 v7, 3, v7
    v_lshl_add_u32 v4, v5, 2, v4
    v_lshlrev_b32 v4, 7, v4
    v_lshl_add_u32 v4, v6, 3, v4
    s_lshl_b32 s60, s56, 1
    s_add_u32 s60, s60, 0
    v_xor_b32 v8, s60, v7
    v_lshl_add_u32 v10, v8, 5, v4
    s_lshl_b32 s60, s56, 1
    s_add_u32 s60, s60, 1
    v_xor_b32 v8, s60, v7
    v_lshl_add_u32 v11, v8, 5, v4
    v_add_u32 v12, 65536, v10
    v_add_u32 v10, 131072, v10
    v_add_u32 v13, 65536, v11
    v_add_u32 v11, 131072, v11
    s_lshl_b32 s60, s55, 11
    s_add_u32 s60, s60, 0
    v_add_u32 v14, s60, v1
    s_waitcnt vmcnt(4)
    s_barrier
    s_add_u32 m0, s88, 16384
    s_xor_b32 s84, s73, 131072
    buffer_load_dwordx4 v220, s[8:11], s84 offen lds
    s_add_u32 m0, s88, 20480
    s_xor_b32 s84, s73, 163840
    buffer_load_dwordx4 v220, s[8:11], s84 offen lds
    s_add_u32 m0, s88, 24576
    s_xor_b32 s84, s73, 196608
    buffer_load_dwordx4 v220, s[8:11], s84 offen lds
    s_add_u32 m0, s88, 28672
    s_xor_b32 s84, s73, 229376
    buffer_load_dwordx4 v220, s[8:11], s84 offen lds
    s_add_u32 m0, s72, 32768
    s_xor_b32 s84, s78, 512
    buffer_load_dwordx4 v216, s[4:7], s84 offen lds
    s_add_u32 m0, s72, 33792
    s_xor_b32 s84, s78, 512
    buffer_load_dwordx4 v217, s[4:7], s84 offen lds
    s_add_u32 m0, s72, 34816
    s_xor_b32 s84, s78, 512
    buffer_load_dwordx4 v218, s[4:7], s84 offen lds
    s_waitcnt vmcnt(10)
    s_add_u32 m0, s72, 35840
    s_xor_b32 s84, s78, 512
    buffer_load_dwordx4 v219, s[4:7], s84 offen lds
    s_waitcnt vmcnt(10)
    s_add_u32 m0, s88, 32768
    s_xor_b32 s84, s73, 262144
    buffer_load_dwordx4 v220, s[8:11], s84 offen lds
    s_waitcnt vmcnt(10)
    s_add_u32 m0, s88, 36864
    s_xor_b32 s84, s73, 294912
    buffer_load_dwordx4 v220, s[8:11], s84 offen lds
    s_waitcnt vmcnt(10)
    s_add_u32 m0, s88, 40960
    s_xor_b32 s84, s73, 327680
    buffer_load_dwordx4 v220, s[8:11], s84 offen lds
    s_waitcnt vmcnt(10)
    s_add_u32 m0, s88, 45056
    s_xor_b32 s84, s73, 360448
    buffer_load_dwordx4 v220, s[8:11], s84 offen lds
    s_waitcnt vmcnt(8)
    s_barrier
    s_add_u32 m0, s72, 49152
    s_xor_b32 s84, s78, 768
    buffer_load_dwordx4 v216, s[4:7], s84 offen lds
    s_add_u32 m0, s72, 50176
    s_xor_b32 s84, s78, 768
    buffer_load_dwordx4 v217, s[4:7], s84 offen lds
    s_add_u32 m0, s72, 51200
    s_xor_b32 s84, s78, 768
    buffer_load_dwordx4 v218, s[4:7], s84 offen lds
    s_waitcnt vmcnt(10)
    s_add_u32 m0, s72, 52224
    s_xor_b32 s84, s78, 768
    buffer_load_dwordx4 v219, s[4:7], s84 offen lds
    s_waitcnt vmcnt(10)
    s_add_u32 m0, s88, 49152
    s_xor_b32 s84, s73, 393216
    buffer_load_dwordx4 v220, s[8:11], s84 offen lds
    s_waitcnt vmcnt(10)
    s_add_u32 m0, s88, 53248
    s_xor_b32 s84, s73, 425984
    buffer_load_dwordx4 v220, s[8:11], s84 offen lds
    s_waitcnt vmcnt(10)
    s_add_u32 m0, s88, 57344
    s_xor_b32 s84, s73, 458752
    buffer_load_dwordx4 v220, s[8:11], s84 offen lds
    s_waitcnt vmcnt(10)
    s_add_u32 m0, s88, 61440
    s_xor_b32 s84, s73, 491520
    buffer_load_dwordx4 v220, s[8:11], s84 offen lds
    s_waitcnt vmcnt(8)
    s_barrier
    s_cmp_eq_u32 s54, 0
    s_cselect_b32 s40, s8, s12
    s_cselect_b32 s41, s9, s13
    s_cselect_b32 s42, s10, s14
    s_mov_b32 s43, 0x20000
    s_mov_b32 exec_hi, 0
    buffer_load_dword v243, v245, s[40:43], 0 offen
    s_mov_b64 exec, -1
    s_bfm_b64 exec, 43, 0
    s_cmp_eq_u32 s55, 0
    s_cselect_b32 s40, s16, s20
    s_cselect_b32 s41, s17, s21
    s_cselect_b32 s42, s18, s22
    s_mov_b32 s43, 0x20000
    buffer_load_dword v243, v242, s[40:43], 0 offen
    s_mov_b64 exec, -1
    s_add_u32 m0, s88, 131072
    s_xor_b32 s84, s74, 0
    buffer_load_dwordx4 v221, s[12:15], s84 offen lds
    s_waitcnt vmcnt(10)
    s_add_u32 m0, s88, 135168
    s_xor_b32 s84, s74, 32768
    buffer_load_dwordx4 v221, s[12:15], s84 offen lds
    s_waitcnt vmcnt(10)
    s_add_u32 m0, s88, 139264
    s_xor_b32 s84, s74, 65536
    buffer_load_dwordx4 v221, s[12:15], s84 offen lds
    s_waitcnt vmcnt(10)
    s_add_u32 m0, s88, 143360
    s_xor_b32 s84, s74, 98304
    buffer_load_dwordx4 v221, s[12:15], s84 offen lds
    s_waitcnt vmcnt(8)
    s_barrier
    s_add_u32 m0, s88, 147456
    s_xor_b32 s84, s74, 131072
    buffer_load_dwordx4 v221, s[12:15], s84 offen lds
    s_add_u32 m0, s88, 151552
    s_xor_b32 s84, s74, 163840
    buffer_load_dwordx4 v221, s[12:15], s84 offen lds
    s_waitcnt vmcnt(8)
    s_barrier
    s_add_u32 m0, s88, 155648
    s_xor_b32 s84, s74, 196608
    buffer_load_dwordx4 v221, s[12:15], s84 offen lds
    s_add_u32 m0, s88, 159744
    s_xor_b32 s84, s74, 229376
    buffer_load_dwordx4 v221, s[12:15], s84 offen lds
    s_mov_b32 s84, 0
    buffer_load_dwordx2 v[208:209], v2, s[4:7], s84 offen offset:0
    s_waitcnt vmcnt(10)
    s_mov_b32 s84, 0
    buffer_load_dwordx2 v[210:211], v2, s[4:7], s84 offen offset:32
    s_barrier
    s_waitcnt vmcnt(10)
    s_mov_b32 s84, 16384
    buffer_load_dwordx2 v[212:213], v2, s[4:7], s84 offen offset:0
    s_waitcnt vmcnt(10)
    s_mov_b32 s84, 16384
    buffer_load_dwordx2 v[214:215], v2, s[4:7], s84 offen offset:32
    s_waitcnt vmcnt(10)
    s_add_u32 m0, s88, 65536
    s_xor_b32 s84, s74, 262144
    buffer_load_dwordx4 v221, s[12:15], s84 offen lds
    s_waitcnt vmcnt(10)
    s_add_u32 m0, s88, 69632
    s_xor_b32 s84, s74, 294912
    buffer_load_dwordx4 v221, s[12:15], s84 offen lds
    s_waitcnt vmcnt(10)
    s_add_u32 m0, s88, 73728
    s_xor_b32 s84, s74, 327680
    buffer_load_dwordx4 v221, s[12:15], s84 offen lds
    s_waitcnt vmcnt(10)
    s_add_u32 m0, s88, 77824
    s_xor_b32 s84, s74, 360448
    buffer_load_dwordx4 v221, s[12:15], s84 offen lds
    s_waitcnt vmcnt(10)
    s_add_u32 m0, s88, 81920
    s_xor_b32 s84, s74, 393216
    buffer_load_dwordx4 v221, s[12:15], s84 offen lds
    s_waitcnt vmcnt(10)
    s_add_u32 m0, s88, 86016
    s_xor_b32 s84, s74, 425984
    buffer_load_dwordx4 v221, s[12:15], s84 offen lds
    s_waitcnt vmcnt(10)
    s_add_u32 m0, s88, 90112
    s_xor_b32 s84, s74, 458752
    buffer_load_dwordx4 v221, s[12:15], s84 offen lds
    s_waitcnt vmcnt(10)
    s_add_u32 m0, s88, 94208
    s_xor_b32 s84, s74, 491520
    buffer_load_dwordx4 v221, s[12:15], s84 offen lds
    s_waitcnt vmcnt(10)
    s_add_u32 m0, s89, 36864
    s_xor_b32 s78, s36, 0
    s_mul_i32 s78, s78, 88064
    buffer_load_dwordx4 v225, s[16:19], s78 offen lds
    s_waitcnt vmcnt(10)
    s_add_u32 m0, s89, 37888
    s_nop 0
    buffer_load_dwordx4 v226, s[16:19], s78 offen lds
    s_waitcnt vmcnt(10)
    s_add_u32 m0, s89, 38912
    s_nop 0
    buffer_load_dwordx4 v227, s[16:19], s78 offen lds
    s_waitcnt vmcnt(10)
    s_add_u32 m0, s89, 49152
    s_xor_b32 s78, s36, 1
    s_mul_i32 s78, s78, 88064
    buffer_load_dwordx4 v225, s[16:19], s78 offen lds
    s_waitcnt vmcnt(10)
    s_add_u32 m0, s89, 50176
    s_nop 0
    buffer_load_dwordx4 v226, s[16:19], s78 offen lds
    s_waitcnt vmcnt(10)
    s_add_u32 m0, s89, 51200
    s_nop 0
    buffer_load_dwordx4 v227, s[16:19], s78 offen lds
    s_waitcnt vmcnt(6)
    s_barrier
    ds_read_b64_tr_b16 v[80:81], v10 offset:0
    ds_read_b64_tr_b16 v[82:83], v10 offset:2048
    ds_read_b64_tr_b16 v[84:85], v11 offset:0
    ds_read_b64_tr_b16 v[86:87], v11 offset:2048
    ds_read_b64_tr_b16 v[88:89], v10 offset:4096
    ds_read_b64_tr_b16 v[90:91], v10 offset:6144
    ds_read_b64_tr_b16 v[92:93], v11 offset:4096
    ds_read_b64_tr_b16 v[94:95], v11 offset:6144
    ds_read_b64_tr_b16 v[96:97], v10 offset:8192
    ds_read_b64_tr_b16 v[98:99], v10 offset:10240
    ds_read_b64_tr_b16 v[100:101], v11 offset:8192
    ds_read_b64_tr_b16 v[102:103], v11 offset:10240
    ds_read_b64_tr_b16 v[104:105], v10 offset:12288
    ds_read_b64_tr_b16 v[106:107], v10 offset:14336
    ds_read_b64_tr_b16 v[108:109], v11 offset:12288
    ds_read_b64_tr_b16 v[110:111], v11 offset:14336
    ds_read_b64_tr_b16 v[112:113], v10 offset:16384
    ds_read_b64_tr_b16 v[114:115], v10 offset:18432
    ds_read_b64_tr_b16 v[116:117], v11 offset:16384
    ds_read_b64_tr_b16 v[118:119], v11 offset:18432
    ds_read_b64_tr_b16 v[120:121], v10 offset:20480
    ds_read_b64_tr_b16 v[122:123], v10 offset:22528
    ds_read_b64_tr_b16 v[124:125], v11 offset:20480
    ds_read_b64_tr_b16 v[126:127], v11 offset:22528
    ds_read_b64_tr_b16 v[128:129], v10 offset:24576
    ds_read_b64_tr_b16 v[130:131], v10 offset:26624
    ds_read_b64_tr_b16 v[132:133], v11 offset:24576
    ds_read_b64_tr_b16 v[134:135], v11 offset:26624
    ds_read_b64_tr_b16 v[136:137], v10 offset:28672
    ds_read_b64_tr_b16 v[138:139], v10 offset:30720
    ds_read_b64_tr_b16 v[140:141], v11 offset:28672
    ds_read_b64_tr_b16 v[142:143], v11 offset:30720
    ds_read_b64_tr_b16 v[144:145], v12 offset:0
    ds_read_b64_tr_b16 v[146:147], v12 offset:2048
    ds_read_b64_tr_b16 v[148:149], v13 offset:0
    ds_read_b64_tr_b16 v[150:151], v13 offset:2048
    ds_read_b64_tr_b16 v[152:153], v12 offset:4096
    ds_read_b64_tr_b16 v[154:155], v12 offset:6144
    ds_read_b64_tr_b16 v[156:157], v13 offset:4096
    ds_read_b64_tr_b16 v[158:159], v13 offset:6144
    ds_read_b64_tr_b16 v[160:161], v12 offset:8192
    ds_read_b64_tr_b16 v[162:163], v12 offset:10240
    ds_read_b64_tr_b16 v[164:165], v13 offset:8192
    ds_read_b64_tr_b16 v[166:167], v13 offset:10240
    ds_read_b64_tr_b16 v[168:169], v12 offset:12288
    ds_read_b64_tr_b16 v[170:171], v12 offset:14336
    ds_read_b64_tr_b16 v[172:173], v13 offset:12288
    ds_read_b64_tr_b16 v[174:175], v13 offset:14336
    ds_read_b64_tr_b16 v[176:177], v12 offset:16384
    ds_read_b64_tr_b16 v[178:179], v12 offset:18432
    ds_read_b64_tr_b16 v[180:181], v13 offset:16384
    ds_read_b64_tr_b16 v[182:183], v13 offset:18432
    ds_read_b64_tr_b16 v[184:185], v12 offset:20480
    ds_read_b64_tr_b16 v[186:187], v12 offset:22528
    ds_read_b64_tr_b16 v[188:189], v13 offset:20480
    ds_read_b64_tr_b16 v[190:191], v13 offset:22528
    ds_read_b64_tr_b16 v[192:193], v12 offset:24576
    ds_read_b64_tr_b16 v[194:195], v12 offset:26624
    ds_read_b64_tr_b16 v[196:197], v13 offset:24576
    ds_read_b64_tr_b16 v[198:199], v13 offset:26624
    ds_read_b64_tr_b16 v[200:201], v12 offset:28672
    ds_read_b64_tr_b16 v[202:203], v12 offset:30720
    ds_read_b64_tr_b16 v[204:205], v13 offset:28672
    ds_read_b64_tr_b16 v[206:207], v13 offset:30720
    s_lshl_b32 s60, s52, 3
    v_mov_b32 v4, s60
    buffer_load_dword v3, v4, s[28:31], 0 offen sc1
    s_waitcnt lgkmcnt(0)
    s_barrier
    v_lshlrev_b32 v7, 3, v0
    v_mov_b32 v15, 2130706432
    v_cmp_gt_u32 vcc, 16, v0
    s_nop 1
    v_cndmask_b32 v15, v15, v7, vcc
    s_lshl_b32 s60, s52, 13
    s_lshl_b32 s61, s53, 1
    s_add_u32 s61, s61, s56
    s_lshl_b32 s61, s61, 9
    s_add_u32 s60, s60, s61
    s_lshl_b32 s61, s55, 8
    s_add_u32 s60, s60, s61
    s_add_u32 s49, s60, 65536
    s_waitcnt vmcnt(0)
    s_mov_b32 s77, 0
L_cenB:
    v_readfirstlane_b32 s60, v3
    s_nop 3
    s_and_b32 s61, s60, 0x0f0f0f0f
    s_lshr_b32 s62, s60, 4
    s_and_b32 s62, s62, 0x0f0f0f0f
    s_add_u32 s61, s61, s62
    s_mul_i32 s61, s61, 0x01010101
    s_lshr_b32 s61, s61, 24
    s_cmp_ge_u32 s61, 8
    s_cbranch_scc1 L_cenB_done
    s_add_u32 s77, s77, 1
    s_cmp_gt_u32 s77, 32768
    s_cbranch_scc1 L_cenB_done
    s_lshl_b32 s61, s52, 3
    v_mov_b32 v4, s61
    buffer_load_dword v3, v4, s[28:31], 0 offen sc1
    s_waitcnt vmcnt(0)
    s_branch L_cenB
L_cenB_done:
    s_lshl_b32 s61, s83, 2
    s_lshl_b32 s61, 8, s61
    s_cmp_eq_u32 s60, s61
    s_cselect_b32 s59, 1, 0
    s_barrier
    ds_read_b128 v[16:19], v14 offset:0
    ds_read_b128 v[20:23], v14 offset:1024
    ds_read_b128 v[24:27], v14 offset:4096
    ds_read_b128 v[28:31], v14 offset:5120
    s_waitcnt lgkmcnt(2)
    v_mfma_f32_16x16x32_bf16 v[48:51], v[80:83], v[16:19], 0
    ds_read_b128 v[32:35], v14 offset:8192
    ds_read_b128 v[36:39], v14 offset:9216
    v_mfma_f32_16x16x32_bf16 v[52:55], v[84:87], v[16:19], 0
    v_mfma_f32_16x16x32_bf16 v[56:59], v[80:83], v[20:23], 0
    v_mfma_f32_16x16x32_bf16 v[60:63], v[84:87], v[20:23], 0
    s_waitcnt lgkmcnt(2)
    v_mfma_f32_16x16x32_bf16 v[48:51], v[88:91], v[24:27], v[48:51]
    ds_read_b128 v[16:19], v14 offset:12288
    ds_read_b128 v[20:23], v14 offset:13312
    v_mfma_f32_16x16x32_bf16 v[52:55], v[92:95], v[24:27], v[52:55]
    v_mfma_f32_16x16x32_bf16 v[56:59], v[88:91], v[28:31], v[56:59]
    v_mfma_f32_16x16x32_bf16 v[60:63], v[92:95], v[28:31], v[60:63]
    s_waitcnt lgkmcnt(2)
    s_barrier
    v_mfma_f32_16x16x32_bf16 v[48:51], v[96:99], v[32:35], v[48:51]
    ds_read_b128 v[24:27], v14 offset:16384
    ds_read_b128 v[28:31], v14 offset:17408
    v_mfma_f32_16x16x32_bf16 v[52:55], v[100:103], v[32:35], v[52:55]
    v_mfma_f32_16x16x32_bf16 v[56:59], v[96:99], v[36:39], v[56:59]
    v_mfma_f32_16x16x32_bf16 v[60:63], v[100:103], v[36:39], v[60:63]
    s_waitcnt lgkmcnt(2)
    v_mfma_f32_16x16x32_bf16 v[48:51], v[104:107], v[16:19], v[48:51]
    ds_read_b128 v[32:35], v14 offset:20480
    ds_read_b128 v[36:39], v14 offset:21504
    v_mfma_f32_16x16x32_bf16 v[52:55], v[108:111], v[16:19], v[52:55]
    v_mfma_f32_16x16x32_bf16 v[56:59], v[104:107], v[20:23], v[56:59]
    v_mfma_f32_16x16x32_bf16 v[60:63], v[108:111], v[20:23], v[60:63]
    s_waitcnt lgkmcnt(2)
    v_mfma_f32_16x16x32_bf16 v[48:51], v[112:115], v[24:27], v[48:51]
    ds_read_b128 v[16:19], v14 offset:24576
    ds_read_b128 v[20:23], v14 offset:25600
    v_mfma_f32_16x16x32_bf16 v[52:55], v[116:119], v[24:27], v[52:55]
    v_mfma_f32_16x16x32_bf16 v[56:59], v[112:115], v[28:31], v[56:59]
    v_mfma_f32_16x16x32_bf16 v[60:63], v[116:119], v[28:31], v[60:63]
    s_waitcnt lgkmcnt(2)
    v_mfma_f32_16x16x32_bf16 v[48:51], v[120:123], v[32:35], v[48:51]
    ds_read_b128 v[24:27], v14 offset:28672
    ds_read_b128 v[28:31], v14 offset:29696
    v_mfma_f32_16x16x32_bf16 v[52:55], v[124:127], v[32:35], v[52:55]
    v_mfma_f32_16x16x32_bf16 v[56:59], v[120:123], v[36:39], v[56:59]
    v_mfma_f32_16x16x32_bf16 v[60:63], v[124:127], v[36:39], v[60:63]
    s_waitcnt lgkmcnt(2)
    s_barrier
    v_mfma_f32_16x16x32_bf16 v[48:51], v[128:131], v[16:19], v[48:51]
    ds_read_b128 v[32:35], v14 offset:32768
    ds_read_b128 v[36:39], v14 offset:33792
    v_mfma_f32_16x16x32_bf16 v[52:55], v[132:135], v[16:19], v[52:55]
    v_mfma_f32_16x16x32_bf16 v[56:59], v[128:131], v[20:23], v[56:59]
    v_mfma_f32_16x16x32_bf16 v[60:63], v[132:135], v[20:23], v[60:63]
    s_waitcnt lgkmcnt(2)
    v_mfma_f32_16x16x32_bf16 v[48:51], v[136:139], v[24:27], v[48:51]
    ds_read_b128 v[16:19], v14 offset:36864
    ds_read_b128 v[20:23], v14 offset:37888
    v_mfma_f32_16x16x32_bf16 v[52:55], v[140:143], v[24:27], v[52:55]
    v_mfma_f32_16x16x32_bf16 v[56:59], v[136:139], v[28:31], v[56:59]
    v_mfma_f32_16x16x32_bf16 v[60:63], v[140:143], v[28:31], v[60:63]
    s_waitcnt lgkmcnt(2)
    v_mfma_f32_16x16x32_bf16 v[48:51], v[144:147], v[32:35], v[48:51]
    ds_read_b128 v[24:27], v14 offset:40960
    ds_read_b128 v[28:31], v14 offset:41984
    v_mfma_f32_16x16x32_bf16 v[52:55], v[148:151], v[32:35], v[52:55]
    v_mfma_f32_16x16x32_bf16 v[56:59], v[144:147], v[36:39], v[56:59]
    v_mfma_f32_16x16x32_bf16 v[60:63], v[148:151], v[36:39], v[60:63]
    s_waitcnt lgkmcnt(2)
    v_mfma_f32_16x16x32_bf16 v[48:51], v[152:155], v[16:19], v[48:51]
    ds_read_b128 v[32:35], v14 offset:45056
    ds_read_b128 v[36:39], v14 offset:46080
    v_mfma_f32_16x16x32_bf16 v[52:55], v[156:159], v[16:19], v[52:55]
    v_mfma_f32_16x16x32_bf16 v[56:59], v[152:155], v[20:23], v[56:59]
    v_mfma_f32_16x16x32_bf16 v[60:63], v[156:159], v[20:23], v[60:63]
    s_waitcnt lgkmcnt(2)
    s_barrier
    v_mfma_f32_16x16x32_bf16 v[48:51], v[160:163], v[24:27], v[48:51]
    ds_read_b128 v[16:19], v14 offset:49152
    ds_read_b128 v[20:23], v14 offset:50176
    v_mfma_f32_16x16x32_bf16 v[52:55], v[164:167], v[24:27], v[52:55]
    v_mfma_f32_16x16x32_bf16 v[56:59], v[160:163], v[28:31], v[56:59]
    v_mfma_f32_16x16x32_bf16 v[60:63], v[164:167], v[28:31], v[60:63]
    s_waitcnt lgkmcnt(2)
    v_mfma_f32_16x16x32_bf16 v[48:51], v[168:171], v[32:35], v[48:51]
    ds_read_b128 v[24:27], v14 offset:53248
    ds_read_b128 v[28:31], v14 offset:54272
    v_mfma_f32_16x16x32_bf16 v[52:55], v[172:175], v[32:35], v[52:55]
    v_mfma_f32_16x16x32_bf16 v[56:59], v[168:171], v[36:39], v[56:59]
    v_mfma_f32_16x16x32_bf16 v[60:63], v[172:175], v[36:39], v[60:63]
    s_waitcnt lgkmcnt(2)
    s_barrier
    v_mfma_f32_16x16x32_bf16 v[48:51], v[176:179], v[16:19], v[48:51]
    ds_read_b128 v[32:35], v14 offset:57344
    ds_read_b128 v[36:39], v14 offset:58368
    v_mfma_f32_16x16x32_bf16 v[52:55], v[180:183], v[16:19], v[52:55]
    v_mfma_f32_16x16x32_bf16 v[56:59], v[176:179], v[20:23], v[56:59]
    v_mfma_f32_16x16x32_bf16 v[60:63], v[180:183], v[20:23], v[60:63]
    s_waitcnt lgkmcnt(2)
    v_mfma_f32_16x16x32_bf16 v[48:51], v[184:187], v[24:27], v[48:51]
    ds_read_b128 v[16:19], v14 offset:61440
    ds_read_b128 v[20:23], v14 offset:62464
    v_mfma_f32_16x16x32_bf16 v[52:55], v[188:191], v[24:27], v[52:55]
    v_mfma_f32_16x16x32_bf16 v[56:59], v[184:187], v[28:31], v[56:59]
    v_mfma_f32_16x16x32_bf16 v[60:63], v[188:191], v[28:31], v[60:63]
    s_waitcnt lgkmcnt(2)
    v_mfma_f32_16x16x32_bf16 v[48:51], v[192:195], v[32:35], v[48:51]
    v_mfma_f32_16x16x32_bf16 v[52:55], v[196:199], v[32:35], v[52:55]
    v_mfma_f32_16x16x32_bf16 v[56:59], v[192:195], v[36:39], v[56:59]
    v_mfma_f32_16x16x32_bf16 v[60:63], v[196:199], v[36:39], v[60:63]
    s_waitcnt lgkmcnt(0)
    v_mfma_f32_16x16x32_bf16 v[48:51], v[200:203], v[16:19], v[48:51]
    v_mfma_f32_16x16x32_bf16 v[52:55], v[204:207], v[16:19], v[52:55]
    v_mfma_f32_16x16x32_bf16 v[56:59], v[200:203], v[20:23], v[56:59]
    v_mfma_f32_16x16x32_bf16 v[60:63], v[204:207], v[20:23], v[60:63]
    s_barrier
    v_lshlrev_b32 v4, 16, v208
    v_and_b32 v5, 0xffff0000, v208
    s_nop 1
    v_pk_add_f32 v[4:5], v[4:5], v[48:49]
    v_cvt_pk_bf16_f32 v208, v4, v5
    v_lshlrev_b32 v6, 16, v209
    v_and_b32 v7, 0xffff0000, v209
    v_pk_add_f32 v[6:7], v[6:7], v[50:51]
    v_cvt_pk_bf16_f32 v209, v6, v7
    v_lshlrev_b32 v4, 16, v210
    v_and_b32 v5, 0xffff0000, v210
    v_pk_add_f32 v[4:5], v[4:5], v[52:53]
    v_cvt_pk_bf16_f32 v210, v4, v5
    v_lshlrev_b32 v6, 16, v211
    v_and_b32 v7, 0xffff0000, v211
    v_pk_add_f32 v[6:7], v[6:7], v[54:55]
    v_cvt_pk_bf16_f32 v211, v6, v7
    v_lshlrev_b32 v4, 16, v212
    v_and_b32 v5, 0xffff0000, v212
    v_pk_add_f32 v[4:5], v[4:5], v[56:57]
    v_cvt_pk_bf16_f32 v212, v4, v5
    v_lshlrev_b32 v6, 16, v213
    v_and_b32 v7, 0xffff0000, v213
    v_pk_add_f32 v[6:7], v[6:7], v[58:59]
    v_cvt_pk_bf16_f32 v213, v6, v7
    v_lshlrev_b32 v4, 16, v214
    v_and_b32 v5, 0xffff0000, v214
    v_pk_add_f32 v[4:5], v[4:5], v[60:61]
    v_cvt_pk_bf16_f32 v214, v4, v5
    v_lshlrev_b32 v6, 16, v215
    v_and_b32 v7, 0xffff0000, v215
    v_pk_add_f32 v[6:7], v[6:7], v[62:63]
    v_cvt_pk_bf16_f32 v215, v6, v7
    s_add_u32 s63, s90, 3145728
    buffer_store_dwordx4 v[208:211], v1, s[32:35], s63 offen offset:0 sc1
    buffer_store_dwordx4 v[212:215], v1, s[32:35], s63 offen offset:1024 sc1
    v_mfma_f32_16x16x32_bf16 v[24:27], v[208:211], v[208:211], 0
    v_mfma_f32_16x16x32_bf16 v[16:19], v[228:231], v[208:211], 0
    v_mfma_f32_16x16x32_bf16 v[28:31], v[212:215], v[212:215], 0
    v_mfma_f32_16x16x32_bf16 v[20:23], v[228:231], v[212:215], 0
    v_mov_b32 v6, 1.0
    s_nop 3
    v_cndmask_b32 v4, 0, v24, s[64:65]
    v_cndmask_b32 v4, v4, v25, s[66:67]
    v_cndmask_b32 v4, v4, v26, s[68:69]
    v_cndmask_b32 v4, v4, v27, s[70:71]
    v_cndmask_b32 v5, 0, v28, s[64:65]
    v_cndmask_b32 v5, v5, v29, s[66:67]
    v_cndmask_b32 v5, v5, v30, s[68:69]
    v_cndmask_b32 v5, v5, v31, s[70:71]
    v_mfma_f32_16x16x4_f32 v[24:27], v6, v4, 0
    s_nop 0
    v_mfma_f32_16x16x4_f32 v[28:31], v6, v5, 0
    v_mov_b32 v32, v16
    v_mov_b32 v34, v20
    s_nop 5
    v_mov_b32 v33, v24
    s_nop 0
    v_mov_b32 v35, v28
    buffer_store_dwordx2 v[32:33], v15, s[32:35], s49 offen offset:0 sc1
    buffer_store_dwordx2 v[34:35], v15, s[32:35], s49 offen offset:128 sc1
    v_bfe_u32 v4, v0, 2, 2
    v_lshrrev_b32 v5, 4, v0
    v_lshl_add_u32 v4, v5, 2, v4
    v_lshlrev_b32 v4, 6, v4
    v_and_b32 v6, 3, v0
    v_lshl_add_u32 v4, v6, 3, v4
    v_and_b32 v5, 1, v5
    v_xor_b32 v6, 0, v5
    v_lshl_add_u32 v6, v6, 5, v4
    v_add_u32 v10, s89, v6
    v_add_u32 v14, 61440, v10
    v_add_u32 v12, s80, v6
    v_xor_b32 v6, 1, v5
    v_lshl_add_u32 v6, v6, 5, v4
    v_add_u32 v11, s89, v6
    v_add_u32 v15, 61440, v11
    v_add_u32 v13, s80, v6
    s_waitcnt vmcnt(0)
    s_add_u32 s63, s90, 3145728
    s_cmp_eq_u32 s59, 1
    s_cbranch_scc1 L_pfB3
    buffer_store_dword v235, v234, s[32:35], 0 offen offset:128 sc1
    s_branch L_pdB3
L_pfB3:
    buffer_store_dword v235, v234, s[32:35], 0 offen offset:128
L_pdB3:
    s_barrier
    s_mov_b32 s77, 0
L_poll1:
    buffer_load_dword v3, v232, s[32:35], s76 offen offset:128 sc1
    s_waitcnt vmcnt(0)
    v_cmp_ne_u32 vcc, 1, v3
    s_add_u32 s77, s77, 1
    s_cmp_gt_u32 s77, 32768
    s_cbranch_scc1 L_poll1_done
    s_cbranch_vccnz L_poll1
L_poll1_done:
    s_barrier
    s_waitcnt lgkmcnt(0)
    s_barrier
    s_add_u32 m0, s88, 0
    s_xor_b32 s84, s37, 0
    buffer_load_dwordx4 v224, s[32:35], s84 offen sc1 lds
    s_add_u32 m0, s88, 4096
    s_xor_b32 s84, s37, 4096
    buffer_load_dwordx4 v224, s[32:35], s84 offen sc1 lds
    s_add_u32 m0, s88, 8192
    s_xor_b32 s84, s37, 8192
    buffer_load_dwordx4 v224, s[32:35], s84 offen sc1 lds
    s_add_u32 m0, s88, 12288
    s_xor_b32 s84, s37, 12288
    buffer_load_dwordx4 v224, s[32:35], s84 offen sc1 lds
    s_add_u32 m0, s88, 16384
    s_xor_b32 s84, s37, 16384
    buffer_load_dwordx4 v224, s[32:35], s84 offen sc1 lds
    s_waitcnt vmcnt(4)
    s_barrier
    s_add_u32 m0, s88, 20480
    s_xor_b32 s84, s37, 20480
    buffer_load_dwordx4 v224, s[32:35], s84 offen sc1 lds
    s_add_u32 m0, s88, 24576
    s_xor_b32 s84, s37, 24576
    buffer_load_dwordx4 v224, s[32:35], s84 offen sc1 lds
    s_add_u32 m0, s88, 28672
    s_xor_b32 s84, s37, 28672
    buffer_load_dwordx4 v224, s[32:35], s84 offen sc1 lds
    s_add_u32 m0, s88, 32768
    s_xor_b32 s84, s37, 32768
    buffer_load_dwordx4 v224, s[32:35], s84 offen sc1 lds
    s_waitcnt vmcnt(7)
    s_barrier
    s_add_u32 m0, s88, 36864
    s_xor_b32 s84, s37, 36864
    buffer_load_dwordx4 v224, s[32:35], s84 offen sc1 lds
    s_add_u32 m0, s89, 36864
    s_xor_b32 s78, s36, 7
    s_mul_i32 s78, s78, 88064
    buffer_load_dwordx4 v225, s[16:19], s78 offen lds
    s_add_u32 m0, s89, 37888
    s_nop 0
    buffer_load_dwordx4 v226, s[16:19], s78 offen lds
    s_add_u32 m0, s89, 38912
    s_nop 0
    buffer_load_dwordx4 v227, s[16:19], s78 offen lds
    s_waitcnt vmcnt(10)
    s_barrier
    s_add_u32 m0, s88, 40960
    s_xor_b32 s84, s37, 40960
    buffer_load_dwordx4 v224, s[32:35], s84 offen sc1 lds
    s_waitcnt vmcnt(10)
    s_add_u32 m0, s89, 49152
    s_xor_b32 s78, s36, 8
    s_mul_i32 s78, s78, 88064
    buffer_load_dwordx4 v225, s[16:19], s78 offen lds
    s_waitcnt vmcnt(10)
    s_add_u32 m0, s89, 50176
    s_nop 0
    buffer_load_dwordx4 v226, s[16:19], s78 offen lds
    s_waitcnt vmcnt(10)
    s_add_u32 m0, s89, 51200
    s_nop 0
    buffer_load_dwordx4 v227, s[16:19], s78 offen lds
    s_barrier
    s_waitcnt vmcnt(10)
    s_add_u32 m0, s88, 45056
    s_xor_b32 s84, s37, 45056
    buffer_load_dwordx4 v224, s[32:35], s84 offen sc1 lds
    s_waitcnt vmcnt(10)
    s_add_u32 m0, s89, 61440
    s_xor_b32 s78, s36, 9
    s_mul_i32 s78, s78, 88064
    buffer_load_dwordx4 v225, s[16:19], s78 offen lds
    s_waitcnt vmcnt(10)
    s_add_u32 m0, s89, 62464
    s_nop 0
    buffer_load_dwordx4 v226, s[16:19], s78 offen lds
    s_waitcnt vmcnt(10)
    s_add_u32 m0, s89, 63488
    s_nop 0
    buffer_load_dwordx4 v227, s[16:19], s78 offen lds
    s_barrier
    s_waitcnt vmcnt(10)
    s_add_u32 m0, s88, 49152
    s_xor_b32 s84, s37, 49152
    buffer_load_dwordx4 v224, s[32:35], s84 offen sc1 lds
    s_waitcnt vmcnt(10)
    s_add_u32 m0, s89, 73728
    s_xor_b32 s78, s36, 10
    s_mul_i32 s78, s78, 88064
    buffer_load_dwordx4 v225, s[16:19], s78 offen lds
    s_waitcnt vmcnt(10)
    s_add_u32 m0, s89, 74752
    s_nop 0
    buffer_load_dwordx4 v226, s[16:19], s78 offen lds
    s_waitcnt vmcnt(10)
    s_add_u32 m0, s89, 75776
    s_nop 0
    buffer_load_dwordx4 v227, s[16:19], s78 offen lds
    s_barrier
    s_waitcnt vmcnt(10)
    s_add_u32 m0, s88, 53248
    s_xor_b32 s84, s37, 53248
    buffer_load_dwordx4 v224, s[32:35], s84 offen sc1 lds
    s_waitcnt vmcnt(10)
    s_add_u32 m0, s89, 0
    s_xor_b32 s78, s36, 11
    s_mul_i32 s78, s78, 88064
    buffer_load_dwordx4 v225, s[16:19], s78 offen lds
    s_waitcnt vmcnt(10)
    s_add_u32 m0, s89, 1024
    s_nop 0
    buffer_load_dwordx4 v226, s[16:19], s78 offen lds
    s_waitcnt vmcnt(10)
    s_add_u32 m0, s89, 2048
    s_nop 0
    buffer_load_dwordx4 v227, s[16:19], s78 offen lds
    s_barrier
    s_waitcnt vmcnt(10)
    s_add_u32 m0, s88, 57344
    s_xor_b32 s84, s37, 57344
    buffer_load_dwordx4 v224, s[32:35], s84 offen sc1 lds
    s_waitcnt vmcnt(10)
    s_add_u32 m0, s89, 12288
    s_xor_b32 s78, s36, 12
    s_mul_i32 s78, s78, 88064
    buffer_load_dwordx4 v225, s[16:19], s78 offen lds
    s_waitcnt vmcnt(10)
    s_add_u32 m0, s89, 13312
    s_nop 0
    buffer_load_dwordx4 v226, s[16:19], s78 offen lds
    s_waitcnt vmcnt(10)
    s_add_u32 m0, s89, 14336
    s_nop 0
    buffer_load_dwordx4 v227, s[16:19], s78 offen lds
    s_barrier
    s_waitcnt vmcnt(10)
    s_add_u32 m0, s88, 61440
    s_xor_b32 s84, s37, 61440
    buffer_load_dwordx4 v224, s[32:35], s84 offen sc1 lds
    s_waitcnt vmcnt(10)
    s_add_u32 m0, s89, 24576
    s_xor_b32 s78, s36, 13
    s_mul_i32 s78, s78, 88064
    buffer_load_dwordx4 v225, s[16:19], s78 offen lds
    s_waitcnt vmcnt(10)
    s_add_u32 m0, s89, 25600
    s_nop 0
    buffer_load_dwordx4 v226, s[16:19], s78 offen lds
    s_waitcnt vmcnt(10)
    s_add_u32 m0, s89, 26624
    s_nop 0
    buffer_load_dwordx4 v227, s[16:19], s78 offen lds
    s_barrier
    s_waitcnt vmcnt(10)
    s_add_u32 m0, s89, 36864
    s_xor_b32 s78, s36, 14
    s_mul_i32 s78, s78, 88064
    buffer_load_dwordx4 v225, s[16:19], s78 offen lds
    s_waitcnt vmcnt(10)
    s_add_u32 m0, s89, 37888
    s_nop 0
    buffer_load_dwordx4 v226, s[16:19], s78 offen lds
    s_waitcnt vmcnt(10)
    s_add_u32 m0, s89, 38912
    s_nop 0
    buffer_load_dwordx4 v227, s[16:19], s78 offen lds
    s_barrier
    s_waitcnt vmcnt(10)
    s_add_u32 m0, s89, 49152
    s_xor_b32 s78, s36, 15
    s_mul_i32 s78, s78, 88064
    buffer_load_dwordx4 v225, s[16:19], s78 offen lds
    s_waitcnt vmcnt(10)
    s_add_u32 m0, s89, 50176
    s_nop 0
    buffer_load_dwordx4 v226, s[16:19], s78 offen lds
    s_waitcnt vmcnt(10)
    s_add_u32 m0, s89, 51200
    s_nop 0
    buffer_load_dwordx4 v227, s[16:19], s78 offen lds
    s_barrier
    s_waitcnt vmcnt(10)
    s_add_u32 m0, s89, 61440
    s_add_u32 s84, s0, 0
    s_cmp_ge_u32 s84, s1
    s_cselect_b32 s2, s1, 0
    s_sub_u32 s84, s84, s2
    s_lshl_b32 s84, s84, 15
    s_add_u32 s84, s84, s81
    buffer_load_dwordx4 v248, s[20:23], s84 offen lds
    s_waitcnt vmcnt(10)
    s_add_u32 m0, s89, 62464
    s_add_u32 s84, s84, 16384
    buffer_load_dwordx4 v248, s[20:23], s84 offen lds
    s_barrier
    s_waitcnt vmcnt(10)
    s_add_u32 m0, s89, 73728
    s_add_u32 s84, s0, 1
    s_cmp_ge_u32 s84, s1
    s_cselect_b32 s2, s1, 0
    s_sub_u32 s84, s84, s2
    s_lshl_b32 s84, s84, 15
    s_add_u32 s84, s84, s81
    buffer_load_dwordx4 v248, s[20:23], s84 offen lds
    s_waitcnt vmcnt(10)
    s_add_u32 m0, s89, 74752
    s_add_u32 s84, s84, 16384
    buffer_load_dwordx4 v248, s[20:23], s84 offen lds
    s_barrier
    s_waitcnt vmcnt(10)
    s_add_u32 m0, s89, 0
    s_add_u32 s84, s0, 2
    s_cmp_ge_u32 s84, s1
    s_cselect_b32 s2, s1, 0
    s_sub_u32 s84, s84, s2
    s_lshl_b32 s84, s84, 15
    s_add_u32 s84, s84, s81
    buffer_load_dwordx4 v248, s[20:23], s84 offen lds
    s_waitcnt vmcnt(10)
    s_add_u32 m0, s89, 1024
    s_add_u32 s84, s84, 16384
    buffer_load_dwordx4 v248, s[20:23], s84 offen lds
    s_barrier
    s_waitcnt vmcnt(10)
    s_add_u32 m0, s89, 12288
    s_add_u32 s84, s0, 3
    s_cmp_ge_u32 s84, s1
    s_cselect_b32 s2, s1, 0
    s_sub_u32 s84, s84, s2
    s_lshl_b32 s84, s84, 15
    s_add_u32 s84, s84, s81
    buffer_load_dwordx4 v248, s[20:23], s84 offen lds
    s_waitcnt vmcnt(10)
    s_add_u32 m0, s89, 13312
    s_add_u32 s84, s84, 16384
    buffer_load_dwordx4 v248, s[20:23], s84 offen lds
    s_barrier
    s_waitcnt vmcnt(10)
    s_add_u32 m0, s89, 24576
    s_add_u32 s84, s0, 4
    s_cmp_ge_u32 s84, s1
    s_cselect_b32 s2, s1, 0
    s_sub_u32 s84, s84, s2
    s_lshl_b32 s84, s84, 15
    s_add_u32 s84, s84, s81
    buffer_load_dwordx4 v248, s[20:23], s84 offen lds
    s_waitcnt vmcnt(10)
    s_add_u32 m0, s89, 25600
    s_add_u32 s84, s84, 16384
    buffer_load_dwordx4 v248, s[20:23], s84 offen lds
    s_waitcnt vmcnt(10)
    s_barrier
    s_add_u32 m0, s89, 36864
    s_add_u32 s84, s0, 5
    s_cmp_ge_u32 s84, s1
    s_cselect_b32 s2, s1, 0
    s_sub_u32 s84, s84, s2
    s_lshl_b32 s84, s84, 15
    s_add_u32 s84, s84, s81
    buffer_load_dwordx4 v248, s[20:23], s84 offen lds
    s_waitcnt vmcnt(10)
    s_add_u32 m0, s89, 37888
    s_add_u32 s84, s84, 16384
    buffer_load_dwordx4 v248, s[20:23], s84 offen lds
    s_barrier
    s_waitcnt vmcnt(10)
    s_add_u32 m0, s80, 0
    s_add_u32 s84, s0, 6
    s_cmp_ge_u32 s84, s1
    s_cselect_b32 s2, s1, 0
    s_sub_u32 s84, s84, s2
    s_lshl_b32 s84, s84, 15
    s_add_u32 s84, s84, s81
    buffer_load_dwordx4 v248, s[20:23], s84 offen lds
    s_waitcnt vmcnt(10)
    s_add_u32 m0, s80, 1024
    s_add_u32 s84, s84, 16384
    buffer_load_dwordx4 v248, s[20:23], s84 offen lds
    s_waitcnt vmcnt(10)
    s_add_u32 m0, s80, 2048
    s_add_u32 s84, s0, 7
    s_cmp_ge_u32 s84, s1
    s_cselect_b32 s2, s1, 0
    s_sub_u32 s84, s84, s2
    s_lshl_b32 s84, s84, 15
    s_add_u32 s84, s84, s81
    buffer_load_dwordx4 v248, s[20:23], s84 offen lds
    s_waitcnt vmcnt(10)
    s_add_u32 m0, s80, 3072
    s_add_u32 s84, s84, 16384
    buffer_load_dwordx4 v248, s[20:23], s84 offen lds
    s_waitcnt vmcnt(10)
    s_add_u32 m0, s80, 4096
    s_add_u32 s84, s0, 8
    s_cmp_ge_u32 s84, s1
    s_cselect_b32 s2, s1, 0
    s_sub_u32 s84, s84, s2
    s_lshl_b32 s84, s84, 15
    s_add_u32 s84, s84, s81
    buffer_load_dwordx4 v248, s[20:23], s84 offen lds
    s_waitcnt vmcnt(10)
    s_add_u32 m0, s80, 5120
    s_add_u32 s84, s84, 16384
    buffer_load_dwordx4 v248, s[20:23], s84 offen lds
    ds_read_b64_tr_b16 v[80:81], v14 offset:0
    ds_read_b64_tr_b16 v[82:83], v14 offset:1024
    ds_read_b64_tr_b16 v[84:85], v15 offset:0
    ds_read_b64_tr_b16 v[86:87], v15 offset:1024
    ds_read_b64_tr_b16 v[88:89], v14 offset:12288
    ds_read_b64_tr_b16 v[90:91], v14 offset:13312
    ds_read_b64_tr_b16 v[92:93], v15 offset:12288
    ds_read_b64_tr_b16 v[94:95], v15 offset:13312
    ds_read_b64_tr_b16 v[96:97], v10 offset:0
    ds_read_b64_tr_b16 v[98:99], v10 offset:1024
    ds_read_b64_tr_b16 v[100:101], v11 offset:0
    ds_read_b64_tr_b16 v[102:103], v11 offset:1024
    s_waitcnt vmcnt(10)
    ds_read_b64_tr_b16 v[104:105], v10 offset:12288
    ds_read_b64_tr_b16 v[106:107], v10 offset:13312
    ds_read_b64_tr_b16 v[108:109], v11 offset:12288
    ds_read_b64_tr_b16 v[110:111], v11 offset:13312
    s_waitcnt vmcnt(8)
    ds_read_b64_tr_b16 v[112:113], v10 offset:24576
    ds_read_b64_tr_b16 v[114:115], v10 offset:25600
    ds_read_b64_tr_b16 v[116:117], v11 offset:24576
    ds_read_b64_tr_b16 v[118:119], v11 offset:25600
    s_waitcnt vmcnt(6)
    ds_read_b64_tr_b16 v[120:121], v10 offset:36864
    ds_read_b64_tr_b16 v[122:123], v10 offset:37888
    ds_read_b64_tr_b16 v[124:125], v11 offset:36864
    ds_read_b64_tr_b16 v[126:127], v11 offset:37888
    s_add_u32 m0, s80, 6144
    s_add_u32 s84, s0, 9
    s_cmp_ge_u32 s84, s1
    s_cselect_b32 s2, s1, 0
    s_sub_u32 s84, s84, s2
    s_lshl_b32 s84, s84, 15
    s_add_u32 s84, s84, s81
    buffer_load_dwordx4 v248, s[20:23], s84 offen lds
    s_add_u32 m0, s80, 7168
    s_add_u32 s84, s84, 16384
    buffer_load_dwordx4 v248, s[20:23], s84 offen lds
    s_add_u32 m0, s80, 8192
    s_add_u32 s84, s0, 10
    s_cmp_ge_u32 s84, s1
    s_cselect_b32 s2, s1, 0
    s_sub_u32 s84, s84, s2
    s_lshl_b32 s84, s84, 15
    s_add_u32 s84, s84, s81
    buffer_load_dwordx4 v248, s[20:23], s84 offen lds
    s_add_u32 m0, s80, 9216
    s_add_u32 s84, s84, 16384
    buffer_load_dwordx4 v248, s[20:23], s84 offen lds
    s_add_u32 m0, s80, 10240
    s_add_u32 s84, s0, 11
    s_cmp_ge_u32 s84, s1
    s_cselect_b32 s2, s1, 0
    s_sub_u32 s84, s84, s2
    s_lshl_b32 s84, s84, 15
    s_add_u32 s84, s84, s81
    buffer_load_dwordx4 v248, s[20:23], s84 offen lds
    s_waitcnt vmcnt(10)
    s_add_u32 m0, s80, 11264
    s_add_u32 s84, s84, 16384
    buffer_load_dwordx4 v248, s[20:23], s84 offen lds
    s_waitcnt vmcnt(10)
    s_add_u32 m0, s80, 12288
    s_add_u32 s84, s0, 12
    s_cmp_ge_u32 s84, s1
    s_cselect_b32 s2, s1, 0
    s_sub_u32 s84, s84, s2
    s_lshl_b32 s84, s84, 15
    s_add_u32 s84, s84, s81
    buffer_load_dwordx4 v248, s[20:23], s84 offen lds
    s_waitcnt vmcnt(10)
    s_add_u32 m0, s80, 13312
    s_add_u32 s84, s84, 16384
    buffer_load_dwordx4 v248, s[20:23], s84 offen lds
    s_waitcnt vmcnt(10)
    s_add_u32 m0, s80, 14336
    s_add_u32 s84, s0, 13
    s_cmp_ge_u32 s84, s1
    s_cselect_b32 s2, s1, 0
    s_sub_u32 s84, s84, s2
    s_lshl_b32 s84, s84, 15
    s_add_u32 s84, s84, s81
    buffer_load_dwordx4 v248, s[20:23], s84 offen lds
    s_waitcnt vmcnt(10)
    s_add_u32 m0, s80, 15360
    s_add_u32 s84, s84, 16384
    buffer_load_dwordx4 v248, s[20:23], s84 offen lds
    s_waitcnt lgkmcnt(0)
    s_waitcnt vmcnt(10)
    s_add_u32 m0, s89, 0
    s_add_u32 s84, s0, 14
    s_cmp_ge_u32 s84, s1
    s_cselect_b32 s2, s1, 0
    s_sub_u32 s84, s84, s2
    s_lshl_b32 s84, s84, 15
    s_add_u32 s84, s84, s81
    buffer_load_dwordx4 v248, s[20:23], s84 offen lds
    s_waitcnt vmcnt(10)
    s_add_u32 m0, s89, 1024
    s_add_u32 s84, s84, 16384
    buffer_load_dwordx4 v248, s[20:23], s84 offen lds
    s_waitcnt vmcnt(10)
    s_add_u32 m0, s89, 2048
    s_add_u32 s84, s0, 15
    s_cmp_ge_u32 s84, s1
    s_cselect_b32 s2, s1, 0
    s_sub_u32 s84, s84, s2
    s_lshl_b32 s84, s84, 15
    s_add_u32 s84, s84, s81
    buffer_load_dwordx4 v248, s[20:23], s84 offen lds
    s_waitcnt vmcnt(10)
    s_add_u32 m0, s89, 12288
    s_add_u32 s84, s84, 16384
    buffer_load_dwordx4 v248, s[20:23], s84 offen lds
    s_waitcnt vmcnt(10)
    s_add_u32 m0, s89, 13312
    s_add_u32 s84, s0, 16
    s_cmp_ge_u32 s84, s1
    s_cselect_b32 s2, s1, 0
    s_sub_u32 s84, s84, s2
    s_lshl_b32 s84, s84, 15
    s_add_u32 s84, s84, s81
    buffer_load_dwordx4 v248, s[20:23], s84 offen lds
    s_waitcnt vmcnt(10)
    s_add_u32 m0, s89, 14336
    s_add_u32 s84, s84, 16384
    buffer_load_dwordx4 v248, s[20:23], s84 offen lds
    s_waitcnt vmcnt(10)
    s_add_u32 m0, s89, 24576
    s_add_u32 s84, s0, 17
    s_cmp_ge_u32 s84, s1
    s_cselect_b32 s2, s1, 0
    s_sub_u32 s84, s84, s2
    s_lshl_b32 s84, s84, 15
    s_add_u32 s84, s84, s81
    buffer_load_dwordx4 v248, s[20:23], s84 offen lds
    s_waitcnt vmcnt(10)
    s_add_u32 m0, s89, 25600
    s_add_u32 s84, s84, 16384
    buffer_load_dwordx4 v248, s[20:23], s84 offen lds
    s_waitcnt vmcnt(10)
    s_add_u32 m0, s89, 26624
    s_add_u32 s84, s0, 18
    s_cmp_ge_u32 s84, s1
    s_cselect_b32 s2, s1, 0
    s_sub_u32 s84, s84, s2
    s_lshl_b32 s84, s84, 15
    s_add_u32 s84, s84, s81
    buffer_load_dwordx4 v248, s[20:23], s84 offen lds
    s_waitcnt vmcnt(10)
    s_add_u32 m0, s89, 36864
    s_add_u32 s84, s84, 16384
    buffer_load_dwordx4 v248, s[20:23], s84 offen lds
    s_waitcnt vmcnt(10)
    s_add_u32 m0, s89, 37888
    s_add_u32 s84, s0, 19
    s_cmp_ge_u32 s84, s1
    s_cselect_b32 s2, s1, 0
    s_sub_u32 s84, s84, s2
    s_lshl_b32 s84, s84, 15
    s_add_u32 s84, s84, s81
    buffer_load_dwordx4 v248, s[20:23], s84 offen lds
    s_waitcnt vmcnt(10)
    s_add_u32 m0, s89, 38912
    s_add_u32 s84, s84, 16384
    buffer_load_dwordx4 v248, s[20:23], s84 offen lds
    s_waitcnt vmcnt(10)
    s_add_u32 m0, s89, 49152
    s_add_u32 s84, s0, 20
    s_cmp_ge_u32 s84, s1
    s_cselect_b32 s2, s1, 0
    s_sub_u32 s84, s84, s2
    s_lshl_b32 s84, s84, 15
    s_add_u32 s84, s84, s81
    buffer_load_dwordx4 v248, s[20:23], s84 offen lds
    s_waitcnt vmcnt(10)
    s_add_u32 m0, s89, 50176
    s_add_u32 s84, s84, 16384
    buffer_load_dwordx4 v248, s[20:23], s84 offen lds
    s_waitcnt vmcnt(10)
    s_add_u32 m0, s89, 51200
    s_add_u32 s84, s0, 21
    s_cmp_ge_u32 s84, s1
    s_cselect_b32 s2, s1, 0
    s_sub_u32 s84, s84, s2
    s_lshl_b32 s84, s84, 15
    s_add_u32 s84, s84, s81
    s_cmp_eq_u32 s55, 1
    s_cselect_b32 s84, 0x40000000, s84
    buffer_load_dwordx4 v248, s[20:23], s84 offen lds
    s_waitcnt vmcnt(10)
    s_add_u32 m0, s89, 61440
    s_add_u32 s84, s84, 16384
    buffer_load_dwordx4 v248, s[20:23], s84 offen lds
    ds_read_b64_tr_b16 v[128:129], v12 offset:0
    ds_read_b64_tr_b16 v[130:131], v12 offset:1024
    ds_read_b64_tr_b16 v[132:133], v13 offset:0
    ds_read_b64_tr_b16 v[134:135], v13 offset:1024
    ds_read_b64_tr_b16 v[136:137], v12 offset:2048
    ds_read_b64_tr_b16 v[138:139], v12 offset:3072
    ds_read_b64_tr_b16 v[140:141], v13 offset:2048
    ds_read_b64_tr_b16 v[142:143], v13 offset:3072
    ds_read_b64_tr_b16 v[144:145], v12 offset:4096
    ds_read_b64_tr_b16 v[146:147], v12 offset:5120
    ds_read_b64_tr_b16 v[148:149], v13 offset:4096
    ds_read_b64_tr_b16 v[150:151], v13 offset:5120
    ds_read_b64_tr_b16 v[152:153], v12 offset:6144
    ds_read_b64_tr_b16 v[154:155], v12 offset:7168
    ds_read_b64_tr_b16 v[156:157], v13 offset:6144
    ds_read_b64_tr_b16 v[158:159], v13 offset:7168
    ds_read_b64_tr_b16 v[160:161], v12 offset:8192
    ds_read_b64_tr_b16 v[162:163], v12 offset:9216
    ds_read_b64_tr_b16 v[164:165], v13 offset:8192
    ds_read_b64_tr_b16 v[166:167], v13 offset:9216
    ds_read_b64_tr_b16 v[168:169], v12 offset:10240
    ds_read_b64_tr_b16 v[170:171], v12 offset:11264
    ds_read_b64_tr_b16 v[172:173], v13 offset:10240
    ds_read_b64_tr_b16 v[174:175], v13 offset:11264
    ds_read_b64_tr_b16 v[176:177], v12 offset:12288
    ds_read_b64_tr_b16 v[178:179], v12 offset:13312
    ds_read_b64_tr_b16 v[180:181], v13 offset:12288
    ds_read_b64_tr_b16 v[182:183], v13 offset:13312
    ds_read_b64_tr_b16 v[184:185], v12 offset:14336
    ds_read_b64_tr_b16 v[186:187], v12 offset:15360
    ds_read_b64_tr_b16 v[188:189], v13 offset:14336
    ds_read_b64_tr_b16 v[190:191], v13 offset:15360
    ds_read_b64_tr_b16 v[192:193], v10 offset:0
    ds_read_b64_tr_b16 v[194:195], v10 offset:1024
    ds_read_b64_tr_b16 v[196:197], v11 offset:0
    ds_read_b64_tr_b16 v[198:199], v11 offset:1024
    ds_read_b64_tr_b16 v[200:201], v10 offset:2048
    ds_read_b64_tr_b16 v[202:203], v10 offset:12288
    ds_read_b64_tr_b16 v[204:205], v11 offset:2048
    ds_read_b64_tr_b16 v[206:207], v11 offset:12288
    s_waitcnt vmcnt(10)
    ds_read_b64_tr_b16 v[208:209], v10 offset:13312
    ds_read_b64_tr_b16 v[210:211], v10 offset:14336
    ds_read_b64_tr_b16 v[212:213], v11 offset:13312
    ds_read_b64_tr_b16 v[214:215], v11 offset:14336
    s_waitcnt vmcnt(8)
    ds_read_b64_tr_b16 v[216:217], v10 offset:24576
    ds_read_b64_tr_b16 v[218:219], v10 offset:25600
    ds_read_b64_tr_b16 v[220:221], v11 offset:24576
    ds_read_b64_tr_b16 v[222:223], v11 offset:25600
    s_waitcnt vmcnt(6)
    ds_read_b64_tr_b16 v[224:225], v10 offset:26624
    ds_read_b64_tr_b16 v[226:227], v10 offset:36864
    ds_read_b64_tr_b16 v[228:229], v11 offset:26624
    ds_read_b64_tr_b16 v[230:231], v11 offset:36864
    s_waitcnt vmcnt(4)
    ds_read_b64_tr_b16 v[232:233], v10 offset:37888
    ds_read_b64_tr_b16 v[234:235], v10 offset:38912
    ds_read_b64_tr_b16 v[236:237], v11 offset:37888
    ds_read_b64_tr_b16 v[238:239], v11 offset:38912
    s_waitcnt vmcnt(2)
    ds_read_b64_tr_b16 v[240:241], v10 offset:49152
    ds_read_b64_tr_b16 v[242:243], v10 offset:50176
    ds_read_b64_tr_b16 v[244:245], v11 offset:49152
    ds_read_b64_tr_b16 v[246:247], v11 offset:50176
    s_waitcnt vmcnt(0)
    ds_read_b64_tr_b16 v[248:249], v10 offset:51200
    ds_read_b64_tr_b16 v[250:251], v14 offset:0
    ds_read_b64_tr_b16 v[252:253], v11 offset:51200
    ds_read_b64_tr_b16 v[254:255], v15 offset:0
    s_lshl_b32 s94, s55, 15
    s_add_u32 s94, s94, 0
    s_mul_i32 s95, s55, 49152
    s_add_u32 s95, s95, 65536
    s_waitcnt lgkmcnt(0)
    s_lshl_b32 s60, s55, 11
    s_add_u32 s60, s60, s94
    v_add_u32 v10, s60, v1
    s_lshl_b32 s60, s55, 11
    s_xor_b32 s60, s60, 2048
    s_add_u32 s60, s60, s94
    v_add_u32 v11, s60, v1
    s_lshl_b32 s60, s55, 11
    s_add_u32 s60, s60, s95
    v_add_u32 v12, s60, v1
    s_lshl_b32 s60, s55, 11
    s_xor_b32 s60, s60, 2048
    s_add_u32 s60, s60, s95
    v_add_u32 v13, s60, v1
    s_barrier
    s_barrier
    ds_read_b128 v[16:19], v10 offset:0
    ds_read_b128 v[20:23], v10 offset:1024
    ds_read_b128 v[24:27], v11 offset:0
    ds_read_b128 v[28:31], v11 offset:1024
    s_waitcnt lgkmcnt(0)
    v_mfma_f32_16x16x32_bf16 v[48:51], v[80:83], v[16:19], 0
    ds_read_b128 v[32:35], v10 offset:4096
    ds_read_b128 v[36:39], v10 offset:5120
    v_mfma_f32_16x16x32_bf16 v[52:55], v[84:87], v[16:19], 0
    ds_read_b128 v[40:43], v11 offset:4096
    ds_read_b128 v[44:47], v11 offset:5120
    v_mfma_f32_16x16x32_bf16 v[56:59], v[80:83], v[20:23], 0
    v_mfma_f32_16x16x32_bf16 v[60:63], v[84:87], v[20:23], 0
    v_mfma_f32_16x16x32_bf16 v[64:67], v[80:83], v[24:27], 0
    v_mfma_f32_16x16x32_bf16 v[68:71], v[84:87], v[24:27], 0
    v_mfma_f32_16x16x32_bf16 v[72:75], v[80:83], v[28:31], 0
    v_mfma_f32_16x16x32_bf16 v[76:79], v[84:87], v[28:31], 0
    s_waitcnt lgkmcnt(0)
    s_barrier
    v_mfma_f32_16x16x32_bf16 v[48:51], v[88:91], v[32:35], v[48:51]
    ds_read_b128 v[16:19], v10 offset:8192
    ds_read_b128 v[20:23], v10 offset:9216
    v_mfma_f32_16x16x32_bf16 v[52:55], v[92:95], v[32:35], v[52:55]
    ds_read_b128 v[24:27], v11 offset:8192
    ds_read_b128 v[28:31], v11 offset:9216
    v_mfma_f32_16x16x32_bf16 v[56:59], v[88:91], v[36:39], v[56:59]
    v_mfma_f32_16x16x32_bf16 v[60:63], v[92:95], v[36:39], v[60:63]
    v_mfma_f32_16x16x32_bf16 v[64:67], v[88:91], v[40:43], v[64:67]
    v_mfma_f32_16x16x32_bf16 v[68:71], v[92:95], v[40:43], v[68:71]
    v_mfma_f32_16x16x32_bf16 v[72:75], v[88:91], v[44:47], v[72:75]
    v_mfma_f32_16x16x32_bf16 v[76:79], v[92:95], v[44:47], v[76:79]
    s_waitcnt lgkmcnt(0)
    s_add_u32 s63, s90, 3145728
    buffer_load_dwordx4 v[80:83], v1, s[32:35], s63 offen offset:0 sc1
    buffer_load_dwordx4 v[84:87], v1, s[32:35], s63 offen offset:1024 sc1
    v_mfma_f32_16x16x32_bf16 v[48:51], v[96:99], v[16:19], v[48:51]
    ds_read_b128 v[32:35], v10 offset:12288
    ds_read_b128 v[36:39], v10 offset:13312
    v_mfma_f32_16x16x32_bf16 v[52:55], v[100:103], v[16:19], v[52:55]
    ds_read_b128 v[40:43], v11 offset:12288
    ds_read_b128 v[44:47], v11 offset:13312
    v_mfma_f32_16x16x32_bf16 v[56:59], v[96:99], v[20:23], v[56:59]
    v_mfma_f32_16x16x32_bf16 v[60:63], v[100:103], v[20:23], v[60:63]
    v_mfma_f32_16x16x32_bf16 v[64:67], v[96:99], v[24:27], v[64:67]
    v_mfma_f32_16x16x32_bf16 v[68:71], v[100:103], v[24:27], v[68:71]
    v_mfma_f32_16x16x32_bf16 v[72:75], v[96:99], v[28:31], v[72:75]
    v_mfma_f32_16x16x32_bf16 v[76:79], v[100:103], v[28:31], v[76:79]
    s_waitcnt lgkmcnt(0)
    s_barrier
    v_mfma_f32_16x16x32_bf16 v[48:51], v[104:107], v[32:35], v[48:51]
    ds_read_b128 v[16:19], v10 offset:16384
    ds_read_b128 v[20:23], v10 offset:17408
    v_mfma_f32_16x16x32_bf16 v[52:55], v[108:111], v[32:35], v[52:55]
    ds_read_b128 v[24:27], v11 offset:16384
    ds_read_b128 v[28:31], v11 offset:17408
    v_mfma_f32_16x16x32_bf16 v[56:59], v[104:107], v[36:39], v[56:59]
    v_mfma_f32_16x16x32_bf16 v[60:63], v[108:111], v[36:39], v[60:63]
    v_mfma_f32_16x16x32_bf16 v[64:67], v[104:107], v[40:43], v[64:67]
    v_mfma_f32_16x16x32_bf16 v[68:71], v[108:111], v[40:43], v[68:71]
    v_mfma_f32_16x16x32_bf16 v[72:75], v[104:107], v[44:47], v[72:75]
    v_mfma_f32_16x16x32_bf16 v[76:79], v[108:111], v[44:47], v[76:79]
    s_waitcnt lgkmcnt(0)
    v_mfma_f32_16x16x32_bf16 v[48:51], v[112:115], v[16:19], v[48:51]
    ds_read_b128 v[32:35], v10 offset:20480
    ds_read_b128 v[36:39], v10 offset:21504
    v_mfma_f32_16x16x32_bf16 v[52:55], v[116:119], v[16:19], v[52:55]
    ds_read_b128 v[40:43], v11 offset:20480
    ds_read_b128 v[44:47], v11 offset:21504
    v_mfma_f32_16x16x32_bf16 v[56:59], v[112:115], v[20:23], v[56:59]
    v_mfma_f32_16x16x32_bf16 v[60:63], v[116:119], v[20:23], v[60:63]
    v_mfma_f32_16x16x32_bf16 v[64:67], v[112:115], v[24:27], v[64:67]
    v_mfma_f32_16x16x32_bf16 v[68:71], v[116:119], v[24:27], v[68:71]
    v_mfma_f32_16x16x32_bf16 v[72:75], v[112:115], v[28:31], v[72:75]
    v_mfma_f32_16x16x32_bf16 v[76:79], v[116:119], v[28:31], v[76:79]
    s_waitcnt lgkmcnt(0)
    v_mfma_f32_16x16x32_bf16 v[48:51], v[120:123], v[32:35], v[48:51]
    ds_read_b128 v[16:19], v10 offset:24576
    ds_read_b128 v[20:23], v10 offset:25600
    v_mfma_f32_16x16x32_bf16 v[52:55], v[124:127], v[32:35], v[52:55]
    ds_read_b128 v[24:27], v11 offset:24576
    ds_read_b128 v[28:31], v11 offset:25600
    v_mfma_f32_16x16x32_bf16 v[56:59], v[120:123], v[36:39], v[56:59]
    v_mfma_f32_16x16x32_bf16 v[60:63], v[124:127], v[36:39], v[60:63]
    v_mfma_f32_16x16x32_bf16 v[64:67], v[120:123], v[40:43], v[64:67]
    v_mfma_f32_16x16x32_bf16 v[68:71], v[124:127], v[40:43], v[68:71]
    v_mfma_f32_16x16x32_bf16 v[72:75], v[120:123], v[44:47], v[72:75]
    v_mfma_f32_16x16x32_bf16 v[76:79], v[124:127], v[44:47], v[76:79]
    s_waitcnt lgkmcnt(0)
    s_lshl_b32 s60, s54, 12
    s_add_u32 s60, s60, 65536
    v_add_u32 v14, s60, v1
    s_xor_b32 s60, s54, 2
    s_lshl_b32 s60, s60, 12
    s_add_u32 s60, s60, 65536
    v_add_u32 v15, s60, v1
    v_and_b32 v4, 15, v0
    v_lshrrev_b32 v5, 4, v0
    v_mul_u32_u24 v4, 80, v4
    v_lshl_add_u32 v4, v5, 3, v4
    s_lshl_b32 s60, s54, 12
    s_add_u32 s60, s60, 81920
    v_add_u32 v96, s60, v4
    v_lshrrev_b32 v4, 2, v0
    v_and_b32 v5, 3, v0
    v_mul_u32_u24 v6, 80, v4
    v_lshl_add_u32 v6, v5, 4, v6
    v_add_u32 v97, s60, v6
    s_lshl_b32 s60, s52, 6
    s_lshl_b32 s61, s55, 5
    s_add_u32 s60, s60, s61
    v_add_u32 v4, s60, v4
    v_lshlrev_b32 v4, 10, v4
    v_lshl_add_u32 v4, v5, 4, v4
    s_lshl_b32 s60, s53, 7
    s_lshl_b32 s61, s56, 6
    s_add_u32 s60, s60, s61
    v_add_u32 v98, s60, v4
    v_mfma_f32_16x16x32_bf16 v[48:51], v[128:131], v[16:19], v[48:51]
    ds_read_b128 v[32:35], v10 offset:28672
    ds_read_b128 v[36:39], v10 offset:29696
    v_mfma_f32_16x16x32_bf16 v[52:55], v[132:135], v[16:19], v[52:55]
    ds_read_b128 v[40:43], v11 offset:28672
    ds_read_b128 v[44:47], v11 offset:29696
    v_mfma_f32_16x16x32_bf16 v[56:59], v[128:131], v[20:23], v[56:59]
    v_mfma_f32_16x16x32_bf16 v[60:63], v[132:135], v[20:23], v[60:63]
    v_mfma_f32_16x16x32_bf16 v[64:67], v[128:131], v[24:27], v[64:67]
    v_mfma_f32_16x16x32_bf16 v[68:71], v[132:135], v[24:27], v[68:71]
    v_mfma_f32_16x16x32_bf16 v[72:75], v[128:131], v[28:31], v[72:75]
    v_mfma_f32_16x16x32_bf16 v[76:79], v[132:135], v[28:31], v[76:79]
    s_waitcnt lgkmcnt(0)
    s_barrier
    v_mfma_f32_16x16x32_bf16 v[48:51], v[136:139], v[32:35], v[48:51]
    ds_read_b128 v[16:19], v12 offset:0
    ds_read_b128 v[20:23], v12 offset:1024
    v_mfma_f32_16x16x32_bf16 v[52:55], v[140:143], v[32:35], v[52:55]
    ds_read_b128 v[24:27], v13 offset:0
    ds_read_b128 v[28:31], v13 offset:1024
    v_mfma_f32_16x16x32_bf16 v[56:59], v[136:139], v[36:39], v[56:59]
    v_mfma_f32_16x16x32_bf16 v[60:63], v[140:143], v[36:39], v[60:63]
    v_mfma_f32_16x16x32_bf16 v[64:67], v[136:139], v[40:43], v[64:67]
    v_mfma_f32_16x16x32_bf16 v[68:71], v[140:143], v[40:43], v[68:71]
    v_mfma_f32_16x16x32_bf16 v[72:75], v[136:139], v[44:47], v[72:75]
    v_mfma_f32_16x16x32_bf16 v[76:79], v[140:143], v[44:47], v[76:79]
    s_waitcnt lgkmcnt(0)
    v_mfma_f32_16x16x32_bf16 v[48:51], v[144:147], v[16:19], v[48:51]
    ds_read_b128 v[32:35], v12 offset:4096
    ds_read_b128 v[36:39], v12 offset:5120
    v_mfma_f32_16x16x32_bf16 v[52:55], v[148:151], v[16:19], v[52:55]
    ds_read_b128 v[40:43], v13 offset:4096
    ds_read_b128 v[44:47], v13 offset:5120
    v_mfma_f32_16x16x32_bf16 v[56:59], v[144:147], v[20:23], v[56:59]
    v_mfma_f32_16x16x32_bf16 v[60:63], v[148:151], v[20:23], v[60:63]
    v_mfma_f32_16x16x32_bf16 v[64:67], v[144:147], v[24:27], v[64:67]
    v_mfma_f32_16x16x32_bf16 v[68:71], v[148:151], v[24:27], v[68:71]
    v_mfma_f32_16x16x32_bf16 v[72:75], v[144:147], v[28:31], v[72:75]
    v_mfma_f32_16x16x32_bf16 v[76:79], v[148:151], v[28:31], v[76:79]
    s_waitcnt lgkmcnt(0)
    v_mfma_f32_16x16x32_bf16 v[48:51], v[152:155], v[32:35], v[48:51]
    ds_read_b128 v[16:19], v12 offset:8192
    ds_read_b128 v[20:23], v12 offset:9216
    v_mfma_f32_16x16x32_bf16 v[52:55], v[156:159], v[32:35], v[52:55]
    ds_read_b128 v[24:27], v13 offset:8192
    ds_read_b128 v[28:31], v13 offset:9216
    v_mfma_f32_16x16x32_bf16 v[56:59], v[152:155], v[36:39], v[56:59]
    v_mfma_f32_16x16x32_bf16 v[60:63], v[156:159], v[36:39], v[60:63]
    v_mfma_f32_16x16x32_bf16 v[64:67], v[152:155], v[40:43], v[64:67]
    v_mfma_f32_16x16x32_bf16 v[68:71], v[156:159], v[40:43], v[68:71]
    v_mfma_f32_16x16x32_bf16 v[72:75], v[152:155], v[44:47], v[72:75]
    v_mfma_f32_16x16x32_bf16 v[76:79], v[156:159], v[44:47], v[76:79]
    s_waitcnt lgkmcnt(0)
    v_mfma_f32_16x16x32_bf16 v[48:51], v[160:163], v[16:19], v[48:51]
    ds_read_b128 v[32:35], v12 offset:12288
    ds_read_b128 v[36:39], v12 offset:13312
    v_mfma_f32_16x16x32_bf16 v[52:55], v[164:167], v[16:19], v[52:55]
    ds_read_b128 v[40:43], v13 offset:12288
    ds_read_b128 v[44:47], v13 offset:13312
    v_mfma_f32_16x16x32_bf16 v[56:59], v[160:163], v[20:23], v[56:59]
    v_mfma_f32_16x16x32_bf16 v[60:63], v[164:167], v[20:23], v[60:63]
    v_mfma_f32_16x16x32_bf16 v[64:67], v[160:163], v[24:27], v[64:67]
    v_mfma_f32_16x16x32_bf16 v[68:71], v[164:167], v[24:27], v[68:71]
    v_mfma_f32_16x16x32_bf16 v[72:75], v[160:163], v[28:31], v[72:75]
    v_mfma_f32_16x16x32_bf16 v[76:79], v[164:167], v[28:31], v[76:79]
    s_waitcnt lgkmcnt(0)
    s_barrier
    v_mfma_f32_16x16x32_bf16 v[48:51], v[168:171], v[32:35], v[48:51]
    ds_read_b128 v[16:19], v12 offset:16384
    ds_read_b128 v[20:23], v12 offset:17408
    v_mfma_f32_16x16x32_bf16 v[52:55], v[172:175], v[32:35], v[52:55]
    ds_read_b128 v[24:27], v13 offset:16384
    ds_read_b128 v[28:31], v13 offset:17408
    v_mfma_f32_16x16x32_bf16 v[56:59], v[168:171], v[36:39], v[56:59]
    v_mfma_f32_16x16x32_bf16 v[60:63], v[172:175], v[36:39], v[60:63]
    v_mfma_f32_16x16x32_bf16 v[64:67], v[168:171], v[40:43], v[64:67]
    v_mfma_f32_16x16x32_bf16 v[68:71], v[172:175], v[40:43], v[68:71]
    v_mfma_f32_16x16x32_bf16 v[72:75], v[168:171], v[44:47], v[72:75]
    v_mfma_f32_16x16x32_bf16 v[76:79], v[172:175], v[44:47], v[76:79]
    s_waitcnt lgkmcnt(0)
    v_mfma_f32_16x16x32_bf16 v[48:51], v[176:179], v[16:19], v[48:51]
    ds_read_b128 v[32:35], v12 offset:20480
    ds_read_b128 v[36:39], v12 offset:21504
    v_mfma_f32_16x16x32_bf16 v[52:55], v[180:183], v[16:19], v[52:55]
    ds_read_b128 v[40:43], v13 offset:20480
    ds_read_b128 v[44:47], v13 offset:21504
    v_mfma_f32_16x16x32_bf16 v[56:59], v[176:179], v[20:23], v[56:59]
    v_mfma_f32_16x16x32_bf16 v[60:63], v[180:183], v[20:23], v[60:63]
    v_mfma_f32_16x16x32_bf16 v[64:67], v[176:179], v[24:27], v[64:67]
    v_mfma_f32_16x16x32_bf16 v[68:71], v[180:183], v[24:27], v[68:71]
    v_mfma_f32_16x16x32_bf16 v[72:75], v[176:179], v[28:31], v[72:75]
    v_mfma_f32_16x16x32_bf16 v[76:79], v[180:183], v[28:31], v[76:79]
    s_waitcnt lgkmcnt(0)
    v_mfma_f32_16x16x32_bf16 v[48:51], v[184:187], v[32:35], v[48:51]
    ds_read_b128 v[16:19], v12 offset:24576
    ds_read_b128 v[20:23], v12 offset:25600
    v_mfma_f32_16x16x32_bf16 v[52:55], v[188:191], v[32:35], v[52:55]
    ds_read_b128 v[24:27], v13 offset:24576
    ds_read_b128 v[28:31], v13 offset:25600
    v_mfma_f32_16x16x32_bf16 v[56:59], v[184:187], v[36:39], v[56:59]
    v_mfma_f32_16x16x32_bf16 v[60:63], v[188:191], v[36:39], v[60:63]
    v_mfma_f32_16x16x32_bf16 v[64:67], v[184:187], v[40:43], v[64:67]
    v_mfma_f32_16x16x32_bf16 v[68:71], v[188:191], v[40:43], v[68:71]
    v_mfma_f32_16x16x32_bf16 v[72:75], v[184:187], v[44:47], v[72:75]
    v_mfma_f32_16x16x32_bf16 v[76:79], v[188:191], v[44:47], v[76:79]
    s_waitcnt lgkmcnt(0)
    v_mfma_f32_16x16x32_bf16 v[48:51], v[192:195], v[16:19], v[48:51]
    ds_read_b128 v[32:35], v12 offset:28672
    ds_read_b128 v[36:39], v12 offset:29696
    v_mfma_f32_16x16x32_bf16 v[52:55], v[196:199], v[16:19], v[52:55]
    ds_read_b128 v[40:43], v13 offset:28672
    ds_read_b128 v[44:47], v13 offset:29696
    v_mfma_f32_16x16x32_bf16 v[56:59], v[192:195], v[20:23], v[56:59]
    v_mfma_f32_16x16x32_bf16 v[60:63], v[196:199], v[20:23], v[60:63]
    v_mfma_f32_16x16x32_bf16 v[64:67], v[192:195], v[24:27], v[64:67]
    v_mfma_f32_16x16x32_bf16 v[68:71], v[196:199], v[24:27], v[68:71]
    v_mfma_f32_16x16x32_bf16 v[72:75], v[192:195], v[28:31], v[72:75]
    v_mfma_f32_16x16x32_bf16 v[76:79], v[196:199], v[28:31], v[76:79]
    s_waitcnt lgkmcnt(0)
    s_barrier
    v_mfma_f32_16x16x32_bf16 v[48:51], v[200:203], v[32:35], v[48:51]
    ds_read_b128 v[16:19], v12 offset:32768
    ds_read_b128 v[20:23], v12 offset:33792
    v_mfma_f32_16x16x32_bf16 v[52:55], v[204:207], v[32:35], v[52:55]
    ds_read_b128 v[24:27], v13 offset:32768
    ds_read_b128 v[28:31], v13 offset:33792
    v_mfma_f32_16x16x32_bf16 v[56:59], v[200:203], v[36:39], v[56:59]
    v_mfma_f32_16x16x32_bf16 v[60:63], v[204:207], v[36:39], v[60:63]
    v_mfma_f32_16x16x32_bf16 v[64:67], v[200:203], v[40:43], v[64:67]
    v_mfma_f32_16x16x32_bf16 v[68:71], v[204:207], v[40:43], v[68:71]
    v_mfma_f32_16x16x32_bf16 v[72:75], v[200:203], v[44:47], v[72:75]
    v_mfma_f32_16x16x32_bf16 v[76:79], v[204:207], v[44:47], v[76:79]
    s_waitcnt lgkmcnt(0)
    v_mfma_f32_16x16x32_bf16 v[48:51], v[208:211], v[16:19], v[48:51]
    ds_read_b128 v[32:35], v12 offset:36864
    ds_read_b128 v[36:39], v12 offset:37888
    v_mfma_f32_16x16x32_bf16 v[52:55], v[212:215], v[16:19], v[52:55]
    ds_read_b128 v[40:43], v13 offset:36864
    ds_read_b128 v[44:47], v13 offset:37888
    v_mfma_f32_16x16x32_bf16 v[56:59], v[208:211], v[20:23], v[56:59]
    v_mfma_f32_16x16x32_bf16 v[60:63], v[212:215], v[20:23], v[60:63]
    v_mfma_f32_16x16x32_bf16 v[64:67], v[208:211], v[24:27], v[64:67]
    v_mfma_f32_16x16x32_bf16 v[68:71], v[212:215], v[24:27], v[68:71]
    v_mfma_f32_16x16x32_bf16 v[72:75], v[208:211], v[28:31], v[72:75]
    v_mfma_f32_16x16x32_bf16 v[76:79], v[212:215], v[28:31], v[76:79]
    s_waitcnt lgkmcnt(0)
    v_mfma_f32_16x16x32_bf16 v[48:51], v[216:219], v[32:35], v[48:51]
    ds_read_b128 v[16:19], v12 offset:40960
    ds_read_b128 v[20:23], v12 offset:41984
    v_mfma_f32_16x16x32_bf16 v[52:55], v[220:223], v[32:35], v[52:55]
    ds_read_b128 v[24:27], v13 offset:40960
    ds_read_b128 v[28:31], v13 offset:41984
    v_mfma_f32_16x16x32_bf16 v[56:59], v[216:219], v[36:39], v[56:59]
    v_mfma_f32_16x16x32_bf16 v[60:63], v[220:223], v[36:39], v[60:63]
    v_mfma_f32_16x16x32_bf16 v[64:67], v[216:219], v[40:43], v[64:67]
    v_mfma_f32_16x16x32_bf16 v[68:71], v[220:223], v[40:43], v[68:71]
    v_mfma_f32_16x16x32_bf16 v[72:75], v[216:219], v[44:47], v[72:75]
    v_mfma_f32_16x16x32_bf16 v[76:79], v[220:223], v[44:47], v[76:79]
    s_waitcnt lgkmcnt(0)
    v_mfma_f32_16x16x32_bf16 v[48:51], v[224:227], v[16:19], v[48:51]
    ds_read_b128 v[32:35], v12 offset:45056
    ds_read_b128 v[36:39], v12 offset:46080
    v_mfma_f32_16x16x32_bf16 v[52:55], v[228:231], v[16:19], v[52:55]
    ds_read_b128 v[40:43], v13 offset:45056
    ds_read_b128 v[44:47], v13 offset:46080
    v_mfma_f32_16x16x32_bf16 v[56:59], v[224:227], v[20:23], v[56:59]
    v_mfma_f32_16x16x32_bf16 v[60:63], v[228:231], v[20:23], v[60:63]
    v_mfma_f32_16x16x32_bf16 v[64:67], v[224:227], v[24:27], v[64:67]
    v_mfma_f32_16x16x32_bf16 v[68:71], v[228:231], v[24:27], v[68:71]
    v_mfma_f32_16x16x32_bf16 v[72:75], v[224:227], v[28:31], v[72:75]
    v_mfma_f32_16x16x32_bf16 v[76:79], v[228:231], v[28:31], v[76:79]
    s_waitcnt lgkmcnt(0)
    s_barrier
    v_mfma_f32_16x16x32_bf16 v[48:51], v[232:235], v[32:35], v[48:51]
    ds_read_b128 v[16:19], v10 offset:0
    ds_read_b128 v[20:23], v10 offset:1024
    v_mfma_f32_16x16x32_bf16 v[52:55], v[236:239], v[32:35], v[52:55]
    ds_read_b128 v[24:27], v11 offset:0
    ds_read_b128 v[28:31], v11 offset:1024
    v_mfma_f32_16x16x32_bf16 v[56:59], v[232:235], v[36:39], v[56:59]
    v_mfma_f32_16x16x32_bf16 v[60:63], v[236:239], v[36:39], v[60:63]
    v_mfma_f32_16x16x32_bf16 v[64:67], v[232:235], v[40:43], v[64:67]
    v_mfma_f32_16x16x32_bf16 v[68:71], v[236:239], v[40:43], v[68:71]
    v_mfma_f32_16x16x32_bf16 v[72:75], v[232:235], v[44:47], v[72:75]
    v_mfma_f32_16x16x32_bf16 v[76:79], v[236:239], v[44:47], v[76:79]
    s_waitcnt lgkmcnt(0)
    v_mfma_f32_16x16x32_bf16 v[48:51], v[240:243], v[16:19], v[48:51]
    ds_read_b128 v[32:35], v10 offset:4096
    ds_read_b128 v[36:39], v10 offset:5120
    v_mfma_f32_16x16x32_bf16 v[52:55], v[244:247], v[16:19], v[52:55]
    ds_read_b128 v[40:43], v11 offset:4096
    ds_read_b128 v[44:47], v11 offset:5120
    v_mfma_f32_16x16x32_bf16 v[56:59], v[240:243], v[20:23], v[56:59]
    v_mfma_f32_16x16x32_bf16 v[60:63], v[244:247], v[20:23], v[60:63]
    v_mfma_f32_16x16x32_bf16 v[64:67], v[240:243], v[24:27], v[64:67]
    v_mfma_f32_16x16x32_bf16 v[68:71], v[244:247], v[24:27], v[68:71]
    v_mfma_f32_16x16x32_bf16 v[72:75], v[240:243], v[28:31], v[72:75]
    v_mfma_f32_16x16x32_bf16 v[76:79], v[244:247], v[28:31], v[76:79]
    s_waitcnt lgkmcnt(0)
    v_mfma_f32_16x16x32_bf16 v[48:51], v[248:251], v[32:35], v[48:51]
    v_mfma_f32_16x16x32_bf16 v[52:55], v[252:255], v[32:35], v[52:55]
    v_mfma_f32_16x16x32_bf16 v[56:59], v[248:251], v[36:39], v[56:59]
    v_mfma_f32_16x16x32_bf16 v[60:63], v[252:255], v[36:39], v[60:63]
    v_mfma_f32_16x16x32_bf16 v[64:67], v[248:251], v[40:43], v[64:67]
    v_mfma_f32_16x16x32_bf16 v[68:71], v[252:255], v[40:43], v[68:71]
    v_mfma_f32_16x16x32_bf16 v[72:75], v[248:251], v[44:47], v[72:75]
    v_mfma_f32_16x16x32_bf16 v[76:79], v[252:255], v[44:47], v[76:79]
    s_nop 4
    ds_write_b128 v14, v[64:67] offset:0
    ds_write_b128 v14, v[68:71] offset:1024
    ds_write_b128 v14, v[72:75] offset:2048
    ds_write_b128 v14, v[76:79] offset:3072
    s_waitcnt vmcnt(0)
    v_lshlrev_b32 v4, 16, v80
    v_and_b32 v5, 0xffff0000, v80
    v_pk_add_f32 v[48:49], v[48:49], v[4:5]
    v_lshlrev_b32 v6, 16, v81
    v_and_b32 v7, 0xffff0000, v81
    v_pk_add_f32 v[50:51], v[50:51], v[6:7]
    v_lshlrev_b32 v4, 16, v82
    v_and_b32 v5, 0xffff0000, v82
    v_pk_add_f32 v[52:53], v[52:53], v[4:5]
    v_lshlrev_b32 v6, 16, v83
    v_and_b32 v7, 0xffff0000, v83
    v_pk_add_f32 v[54:55], v[54:55], v[6:7]
    v_lshlrev_b32 v4, 16, v84
    v_and_b32 v5, 0xffff0000, v84
    v_pk_add_f32 v[56:57], v[56:57], v[4:5]
    v_lshlrev_b32 v6, 16, v85
    v_and_b32 v7, 0xffff0000, v85
    v_pk_add_f32 v[58:59], v[58:59], v[6:7]
    v_lshlrev_b32 v4, 16, v86
    v_and_b32 v5, 0xffff0000, v86
    v_pk_add_f32 v[60:61], v[60:61], v[4:5]
    v_lshlrev_b32 v6, 16, v87
    v_and_b32 v7, 0xffff0000, v87
    v_pk_add_f32 v[62:63], v[62:63], v[6:7]
    s_waitcnt lgkmcnt(0)
    s_barrier
    ds_read_b128 v[16:19], v15 offset:0
    ds_read_b128 v[20:23], v15 offset:1024
    ds_read_b128 v[24:27], v15 offset:2048
    ds_read_b128 v[28:31], v15 offset:3072
    s_waitcnt lgkmcnt(3)
    v_pk_add_f32 v[48:49], v[48:49], v[16:17]
    v_pk_add_f32 v[50:51], v[50:51], v[18:19]
    v_cvt_pk_bf16_f32 v32, v48, v49
    v_cvt_pk_bf16_f32 v33, v50, v51
    ds_write_b64 v96, v[32:33] offset:0
    s_waitcnt lgkmcnt(3)
    v_pk_add_f32 v[52:53], v[52:53], v[20:21]
    v_pk_add_f32 v[54:55], v[54:55], v[22:23]
    v_cvt_pk_bf16_f32 v34, v52, v53
    v_cvt_pk_bf16_f32 v35, v54, v55
    ds_write_b64 v96, v[34:35] offset:32
    ds_read_b128 v[88:91], v97 offset:0
    s_waitcnt lgkmcnt(4)
    v_pk_add_f32 v[56:57], v[56:57], v[24:25]
    v_pk_add_f32 v[58:59], v[58:59], v[26:27]
    v_cvt_pk_bf16_f32 v36, v56, v57
    v_cvt_pk_bf16_f32 v37, v58, v59
    ds_write_b64 v96, v[36:37] offset:1280
    s_waitcnt lgkmcnt(4)
    v_pk_add_f32 v[60:61], v[60:61], v[28:29]
    v_pk_add_f32 v[62:63], v[62:63], v[30:31]
    v_cvt_pk_bf16_f32 v38, v60, v61
    v_cvt_pk_bf16_f32 v39, v62, v63
    ds_write_b64 v96, v[38:39] offset:1312
    ds_read_b128 v[92:95], v97 offset:1280
    s_waitcnt lgkmcnt(3)
    s_mov_b32 s84, 0
    buffer_store_dwordx4 v[88:91], v98, s[24:27], s84 offen nt
    s_waitcnt lgkmcnt(0)
    s_mov_b32 s84, 16384
    buffer_store_dwordx4 v[92:95], v98, s[24:27], s84 offen nt
    s_endpgm
L_groupA:
    s_getreg_b32 s83, hwreg(HW_REG_XCC_ID, 0, 4)
    s_add_u32 s60, s53, s52
    s_and_b32 s60, s60, 7
    s_lshl_b32 s58, s60, 1
    s_lshr_b32 s60, s52, 3
    s_mul_i32 s60, s60, 5
    s_lshl_b32 s61, s53, 1
    s_add_u32 s60, s60, s61
    s_cmp_ge_u32 s60, 21
    s_cselect_b32 s61, 21, 0
    s_sub_u32 s0, s60, s61
    s_lshl_b32 s74, s58, 15
    s_lshl_b32 s75, s58, 12
    s_lshl_b32 s76, s52, 9
    s_mul_i32 s89, s54, 3072
    s_add_u32 s89, s89, 65536
    s_lshl_b32 s80, s54, 14
    s_add_u32 s80, s80, 0
    s_sub_u32 s1, 22, s55
    s_mul_i32 s81, s55, 720896
    s_mul_i32 s82, s55, 90112
    s_mul_i32 s79, s52, 176128
    s_add_u32 s79, s79, 5242880
    s_lshl_b32 s99, s52, 16
    s_add_u32 s99, s99, 1048576
    s_waitcnt lgkmcnt(0)
    s_mov_b32 s4, s36
    s_and_b32 s5, s37, 0xffff
    s_mov_b32 s6, 2097152
    s_mov_b32 s7, 0x20000
    s_mov_b32 s8, s38
    s_and_b32 s9, s39, 0xffff
    s_mov_b32 s10, 524288
    s_mov_b32 s11, 0x20000
    s_mov_b32 s32, s50
    s_and_b32 s33, s51, 0xffff
    s_mov_b32 s34, 11534336
    s_mov_b32 s35, 0x20000
    s_mov_b32 s28, s48
    s_and_b32 s29, s49, 0xffff
    s_mov_b32 s30, 256
    s_mov_b32 s31, 0x20000
    s_mov_b32 s12, s40
    s_and_b32 s13, s41, 0xffff
    s_mov_b32 s14, 524288
    s_mov_b32 s15, 0x20000
    s_mov_b32 s16, s42
    s_and_b32 s17, s43, 0xffff
    s_mov_b32 s18, 1409024
    s_mov_b32 s19, 0x20000
    s_mov_b32 s20, s44
    s_and_b32 s21, s45, 0xffff
    s_mov_b32 s22, 1409024
    s_mov_b32 s23, 0x20000
    s_mov_b32 s36, s58
    s_lshl_b32 s37, s36, 12
    s_or_b32 s60, s53, s54
    s_cmp_eq_u32 s60, 0
    s_cselect_b32 s60, 0, 2130706432
    v_lshlrev_b32 v4, 3, v0
    v_add_u32 v4, s60, v4
    v_mov_b32 v6, 0
    v_mov_b32 v7, 0
    buffer_store_dwordx2 v[6:7], v4, s[32:35], s76 offen sc1
    v_mov_b32 v12, 0x3f803f80
    v_mov_b32 v13, 0x3f803f80
    v_mov_b32 v14, 0x3f803f80
    v_mov_b32 v15, 0x3f803f80
    s_mov_b32 s64, 0x100001
    s_mov_b32 s65, 0x10000100
    s_mov_b32 s66, 0x200002
    s_mov_b32 s67, 0x20000200
    s_mov_b32 s68, 0x400004
    s_mov_b32 s69, 0x40000400
    s_mov_b32 s70, 0x800008
    s_mov_b32 s71, 0x80000800
    v_and_b32 v16, 31, v0
    v_lshlrev_b32 v16, 2, v16
    s_lshl_b32 s60, s53, 2
    s_add_u32 s60, s60, s54
    s_lshl_b32 s60, s60, 2
    s_add_u32 s60, s60, s76
    v_mov_b32 v18, 2130706432
    v_mov_b32 v6, s60
    v_cmp_eq_u32 vcc, 0, v0
    s_nop 1
    v_cndmask_b32 v18, v18, v6, vcc
    v_mov_b32 v19, 1
    v_mov_b32 v148, 1.0
    v_mov_b32 v149, 1.0
    v_and_b32 v4, 15, v0
    v_lshrrev_b32 v5, 4, v0
    s_lshl_b32 s60, s55, 13
    s_add_u32 s60, s60, 65536
    v_add_u32 v6, 0, v5
    v_xor_b32 v6, v6, v4
    v_lshlrev_b32 v6, 4, v6
    v_lshl_add_u32 v6, v4, 8, v6
    v_add_u32 v20, s60, v6
    v_add_u32 v6, 4, v5
    v_xor_b32 v6, v6, v4
    v_lshlrev_b32 v6, 4, v6
    v_lshl_add_u32 v6, v4, 8, v6
    v_add_u32 v21, s60, v6
    v_add_u32 v6, 8, v5
    v_xor_b32 v6, v6, v4
    v_lshlrev_b32 v6, 4, v6
    v_lshl_add_u32 v6, v4, 8, v6
    v_add_u32 v22, s60, v6
    v_add_u32 v6, 12, v5
    v_xor_b32 v6, v6, v4
    v_lshlrev_b32 v6, 4, v6
    v_lshl_add_u32 v6, v4, 8, v6
    v_add_u32 v23, s60, v6
    v_bfe_u32 v4, v0, 2, 2
    v_lshrrev_b32 v5, 4, v0
    v_and_b32 v6, 3, v0
    v_lshrrev_b32 v7, 1, v4
    v_and_b32 v8, 1, v5
    v_lshl_or_b32 v7, v8, 1, v7
    v_lshl_add_u32 v4, v5, 3, v4
    v_lshlrev_b32 v4, 7, v4
    v_lshl_add_u32 v4, v6, 3, v4
    s_lshl_b32 s60, s56, 1
    s_add_u32 s60, s60, 0
    v_xor_b32 v8, s60, v7
    v_lshl_add_u32 v24, v8, 5, v4
    s_lshl_b32 s60, s56, 1
    s_add_u32 s60, s60, 1
    v_xor_b32 v8, s60, v7
    v_lshl_add_u32 v25, v8, 5, v4
    s_lshl_b32 s90, s52, 16
    s_lshl_b32 s60, s53, 1
    s_add_u32 s60, s60, s56
    s_lshl_b32 s60, s60, 12
    s_add_u32 s90, s90, s60
    s_lshl_b32 s61, s55, 11
    s_add_u32 s90, s90, s61
    s_lshl_b32 s60, s52, 16
    s_add_u32 s60, s60, s88
    s_add_u32 s60, s60, 1048576
    v_add_u32 v236, s60, v1
    s_mul_i32 s60, s53, 12
    s_mul_i32 s61, s53, 10
    s_add_u32 s61, s61, 6
    s_cmp_ge_u32 s53, 3
    s_cselect_b32 s60, s61, s60
    s_cselect_b32 s62, 1, 0
    s_lshr_b32 s61, s60, 1
    s_mul_i32 s63, s54, 3
    s_add_u32 s91, s63, 1
    s_lshr_b32 s91, s91, 1
    s_cmp_eq_u32 s54, 3
    s_cselect_b32 s93, s62, 0
    s_sub_u32 s91, s91, s93
    s_add_u32 s91, s91, s61
    s_mul_i32 s92, s55, 3
    s_add_u32 s92, s92, 1
    s_add_u32 s92, s92, s61
    s_lshl_b32 s93, s93, 1
    s_sub_u32 s63, s63, s93
    s_add_u32 s60, s60, s63
    s_lshl_b32 s60, s60, 5
    s_and_b32 s62, s62, s55
    s_xor_b32 s93, s62, 1
    v_add_u32 v4, 0, v0
    v_mul_u32_u24 v5, 0xaaab, v4
    v_lshrrev_b32 v5, 18, v5
    v_mul_u32_u24 v6, 6, v5
    v_sub_u32 v6, v4, v6
    v_mul_u32_u24 v5, 2752, v5
    v_lshl_add_u32 v5, v6, 4, v5
    v_add_u32 v237, s60, v5
    s_lshl_b32 s61, s56, 2
    s_sub_u32 s61, 4, s61
    v_subrev_u32 v6, s61, v6
    v_cmp_gt_u32 vcc, 2, v6
    s_cmp_eq_u32 s93, 0
    s_cselect_b64 s[86:87], vcc, 0
    v_mov_b32 v7, 2130706432
    v_cndmask_b32 v237, v237, v7, s[86:87]
    v_add_u32 v4, 64, v0
    v_mul_u32_u24 v5, 0xaaab, v4
    v_lshrrev_b32 v5, 18, v5
    v_mul_u32_u24 v6, 6, v5
    v_sub_u32 v6, v4, v6
    v_mul_u32_u24 v5, 2752, v5
    v_lshl_add_u32 v5, v6, 4, v5
    v_add_u32 v238, s60, v5
    s_lshl_b32 s61, s56, 2
    s_sub_u32 s61, 4, s61
    v_subrev_u32 v6, s61, v6
    v_cmp_gt_u32 vcc, 2, v6
    s_cmp_eq_u32 s93, 0
    s_cselect_b64 s[86:87], vcc, 0
    v_mov_b32 v7, 2130706432
    v_cndmask_b32 v238, v238, v7, s[86:87]
    v_add_u32 v4, 128, v0
    v_mul_u32_u24 v5, 0xaaab, v4
    v_lshrrev_b32 v5, 18, v5
    v_mul_u32_u24 v6, 6, v5
    v_sub_u32 v6, v4, v6
    v_mul_u32_u24 v5, 2752, v5
    v_lshl_add_u32 v5, v6, 4, v5
    v_add_u32 v239, s60, v5
    s_lshl_b32 s61, s56, 2
    s_sub_u32 s61, 4, s61
    v_subrev_u32 v6, s61, v6
    v_cmp_gt_u32 vcc, 2, v6
    s_cmp_eq_u32 s93, 0
    s_cselect_b64 s[86:87], vcc, 0
    v_mov_b32 v7, 2130706432
    v_cndmask_b32 v239, v239, v7, s[86:87]
    v_lshrrev_b32 v4, 2, v0
    v_bfe_u32 v5, v0, 1, 1
    v_bfe_u32 v6, v0, 4, 1
    v_xor_b32 v5, v5, v6
    v_lshlrev_b32 v5, 5, v5
    v_and_b32 v6, 1, v0
    v_lshl_add_u32 v5, v6, 4, v5
    v_lshl_add_u32 v4, v4, 10, v5
    s_lshl_b32 s60, s53, 7
    s_lshl_b32 s61, s56, 6
    s_add_u32 s60, s60, s61
    v_add_u32 v240, s60, v4
    s_lshl_b32 s60, s56, 11
    v_add_u32 v241, s60, v1
    s_barrier
    ds_read_b128 v[32:35], v20 offset:0
    ds_read_b128 v[36:39], v20 offset:4096
    ds_read_b64_tr_b16 v[164:165], v24 offset:0
    ds_read_b64_tr_b16 v[166:167], v24 offset:512
    ds_read_b64_tr_b16 v[168:169], v25 offset:0
    ds_read_b64_tr_b16 v[170:171], v25 offset:512
    s_waitcnt lgkmcnt(0)
    v_mfma_f32_16x16x32_bf16 v[64:67], v[164:167], v[32:35], 0
    ds_read_b128 v[40:43], v21 offset:0
    ds_read_b128 v[44:47], v21 offset:4096
    v_mfma_f32_16x16x32_bf16 v[68:71], v[168:171], v[32:35], 0
    ds_read_b64_tr_b16 v[172:173], v24 offset:4096
    ds_read_b64_tr_b16 v[174:175], v24 offset:4608
    v_mfma_f32_16x16x32_bf16 v[72:75], v[164:167], v[36:39], 0
    ds_read_b64_tr_b16 v[176:177], v25 offset:4096
    ds_read_b64_tr_b16 v[178:179], v25 offset:4608
    v_mfma_f32_16x16x32_bf16 v[76:79], v[168:171], v[36:39], 0
    v_mfma_f32_16x16x32_bf16 v[152:155], v[164:167], v[12:15], 0
    v_mfma_f32_16x16x32_bf16 v[156:159], v[168:171], v[12:15], 0
    v_mfma_f32_16x16x32_bf16 v[112:115], v[12:15], v[32:35], 0
    v_mfma_f32_16x16x32_bf16 v[120:123], v[32:35], v[32:35], 0
    v_mfma_f32_16x16x32_bf16 v[116:119], v[12:15], v[36:39], 0
    v_mfma_f32_16x16x32_bf16 v[124:127], v[36:39], v[36:39], 0
    s_waitcnt lgkmcnt(0)
    v_mfma_f32_16x16x32_bf16 v[64:67], v[172:175], v[40:43], v[64:67]
    ds_read_b128 v[32:35], v22 offset:0
    ds_read_b128 v[36:39], v22 offset:4096
    v_mfma_f32_16x16x32_bf16 v[68:71], v[176:179], v[40:43], v[68:71]
    ds_read_b64_tr_b16 v[164:165], v24 offset:8192
    ds_read_b64_tr_b16 v[166:167], v24 offset:8704
    v_mfma_f32_16x16x32_bf16 v[72:75], v[172:175], v[44:47], v[72:75]
    ds_read_b64_tr_b16 v[168:169], v25 offset:8192
    ds_read_b64_tr_b16 v[170:171], v25 offset:8704
    v_mfma_f32_16x16x32_bf16 v[76:79], v[176:179], v[44:47], v[76:79]
    v_mfma_f32_16x16x32_bf16 v[152:155], v[172:175], v[12:15], v[152:155]
    v_mfma_f32_16x16x32_bf16 v[156:159], v[176:179], v[12:15], v[156:159]
    v_mfma_f32_16x16x32_bf16 v[112:115], v[12:15], v[40:43], v[112:115]
    v_mfma_f32_16x16x32_bf16 v[120:123], v[40:43], v[40:43], v[120:123]
    v_mfma_f32_16x16x32_bf16 v[116:119], v[12:15], v[44:47], v[116:119]
    v_mfma_f32_16x16x32_bf16 v[124:127], v[44:47], v[44:47], v[124:127]
    s_waitcnt lgkmcnt(0)
    v_mfma_f32_16x16x32_bf16 v[64:67], v[164:167], v[32:35], v[64:67]
    ds_read_b128 v[40:43], v23 offset:0
    ds_read_b128 v[44:47], v23 offset:4096
    v_mfma_f32_16x16x32_bf16 v[68:71], v[168:171], v[32:35], v[68:71]
    ds_read_b64_tr_b16 v[172:173], v24 offset:12288
    ds_read_b64_tr_b16 v[174:175], v24 offset:12800
    v_mfma_f32_16x16x32_bf16 v[72:75], v[164:167], v[36:39], v[72:75]
    ds_read_b64_tr_b16 v[176:177], v25 offset:12288
    ds_read_b64_tr_b16 v[178:179], v25 offset:12800
    v_mfma_f32_16x16x32_bf16 v[76:79], v[168:171], v[36:39], v[76:79]
    v_mfma_f32_16x16x32_bf16 v[152:155], v[164:167], v[12:15], v[152:155]
    v_mfma_f32_16x16x32_bf16 v[156:159], v[168:171], v[12:15], v[156:159]
    v_mfma_f32_16x16x32_bf16 v[112:115], v[12:15], v[32:35], v[112:115]
    v_mfma_f32_16x16x32_bf16 v[120:123], v[32:35], v[32:35], v[120:123]
    v_mfma_f32_16x16x32_bf16 v[116:119], v[12:15], v[36:39], v[116:119]
    v_mfma_f32_16x16x32_bf16 v[124:127], v[36:39], v[36:39], v[124:127]
    s_waitcnt lgkmcnt(0)
    s_waitcnt vmcnt(0)
    s_lshl_b32 s60, s83, 2
    s_lshl_b32 s60, 1, s60
    v_mov_b32 v4, s60
    s_lshl_b32 s60, s52, 3
    s_cmp_eq_u32 s54, 0
    s_cselect_b32 s60, s60, 2130706432
    v_mov_b32 v5, 2130706432
    v_mov_b32 v6, s60
    v_cmp_eq_u32 vcc, 0, v0
    s_nop 1
    v_cndmask_b32 v5, v5, v6, vcc
    buffer_atomic_add v4, v5, s[28:31], 0 offen sc1
    s_barrier
    v_mfma_f32_16x16x32_bf16 v[64:67], v[172:175], v[40:43], v[64:67]
    ds_read_b128 v[32:35], v20 offset:16384
    ds_read_b128 v[36:39], v20 offset:20480
    v_mfma_f32_16x16x32_bf16 v[68:71], v[176:179], v[40:43], v[68:71]
    ds_read_b64_tr_b16 v[164:165], v24 offset:16384
    ds_read_b64_tr_b16 v[166:167], v24 offset:16896
    v_mfma_f32_16x16x32_bf16 v[72:75], v[172:175], v[44:47], v[72:75]
    ds_read_b64_tr_b16 v[168:169], v25 offset:16384
    ds_read_b64_tr_b16 v[170:171], v25 offset:16896
    v_mfma_f32_16x16x32_bf16 v[76:79], v[176:179], v[44:47], v[76:79]
    v_mfma_f32_16x16x32_bf16 v[152:155], v[172:175], v[12:15], v[152:155]
    v_mfma_f32_16x16x32_bf16 v[156:159], v[176:179], v[12:15], v[156:159]
    v_mfma_f32_16x16x32_bf16 v[112:115], v[12:15], v[40:43], v[112:115]
    v_mfma_f32_16x16x32_bf16 v[120:123], v[40:43], v[40:43], v[120:123]
    v_mfma_f32_16x16x32_bf16 v[116:119], v[12:15], v[44:47], v[116:119]
    v_mfma_f32_16x16x32_bf16 v[124:127], v[44:47], v[44:47], v[124:127]
    s_waitcnt lgkmcnt(0)
    v_mfma_f32_16x16x32_bf16 v[64:67], v[164:167], v[32:35], v[64:67]
    ds_read_b128 v[40:43], v21 offset:16384
    ds_read_b128 v[44:47], v21 offset:20480
    v_mfma_f32_16x16x32_bf16 v[68:71], v[168:171], v[32:35], v[68:71]
    ds_read_b64_tr_b16 v[172:173], v24 offset:20480
    ds_read_b64_tr_b16 v[174:175], v24 offset:20992
    v_mfma_f32_16x16x32_bf16 v[72:75], v[164:167], v[36:39], v[72:75]
    ds_read_b64_tr_b16 v[176:177], v25 offset:20480
    ds_read_b64_tr_b16 v[178:179], v25 offset:20992
    v_mfma_f32_16x16x32_bf16 v[76:79], v[168:171], v[36:39], v[76:79]
    v_mfma_f32_16x16x32_bf16 v[152:155], v[164:167], v[12:15], v[152:155]
    v_mfma_f32_16x16x32_bf16 v[156:159], v[168:171], v[12:15], v[156:159]
    v_mfma_f32_16x16x32_bf16 v[112:115], v[12:15], v[32:35], v[112:115]
    v_mfma_f32_16x16x32_bf16 v[120:123], v[32:35], v[32:35], v[120:123]
    v_mfma_f32_16x16x32_bf16 v[116:119], v[12:15], v[36:39], v[116:119]
    v_mfma_f32_16x16x32_bf16 v[124:127], v[36:39], v[36:39], v[124:127]
    s_waitcnt lgkmcnt(0)
    v_mfma_f32_16x16x32_bf16 v[64:67], v[172:175], v[40:43], v[64:67]
    ds_read_b128 v[32:35], v22 offset:16384
    ds_read_b128 v[36:39], v22 offset:20480
    v_mfma_f32_16x16x32_bf16 v[68:71], v[176:179], v[40:43], v[68:71]
    ds_read_b64_tr_b16 v[164:165], v24 offset:24576
    ds_read_b64_tr_b16 v[166:167], v24 offset:25088
    v_mfma_f32_16x16x32_bf16 v[72:75], v[172:175], v[44:47], v[72:75]
    ds_read_b64_tr_b16 v[168:169], v25 offset:24576
    ds_read_b64_tr_b16 v[170:171], v25 offset:25088
    v_mfma_f32_16x16x32_bf16 v[76:79], v[176:179], v[44:47], v[76:79]
    v_mfma_f32_16x16x32_bf16 v[152:155], v[172:175], v[12:15], v[152:155]
    v_mfma_f32_16x16x32_bf16 v[156:159], v[176:179], v[12:15], v[156:159]
    v_mfma_f32_16x16x32_bf16 v[112:115], v[12:15], v[40:43], v[112:115]
    v_mfma_f32_16x16x32_bf16 v[120:123], v[40:43], v[40:43], v[120:123]
    v_mfma_f32_16x16x32_bf16 v[116:119], v[12:15], v[44:47], v[116:119]
    v_mfma_f32_16x16x32_bf16 v[124:127], v[44:47], v[44:47], v[124:127]
    s_waitcnt lgkmcnt(0)
    v_mfma_f32_16x16x32_bf16 v[64:67], v[164:167], v[32:35], v[64:67]
    ds_read_b128 v[40:43], v23 offset:16384
    ds_read_b128 v[44:47], v23 offset:20480
    v_mfma_f32_16x16x32_bf16 v[68:71], v[168:171], v[32:35], v[68:71]
    ds_read_b64_tr_b16 v[172:173], v24 offset:28672
    ds_read_b64_tr_b16 v[174:175], v24 offset:29184
    v_mfma_f32_16x16x32_bf16 v[72:75], v[164:167], v[36:39], v[72:75]
    ds_read_b64_tr_b16 v[176:177], v25 offset:28672
    ds_read_b64_tr_b16 v[178:179], v25 offset:29184
    v_mfma_f32_16x16x32_bf16 v[76:79], v[168:171], v[36:39], v[76:79]
    v_mfma_f32_16x16x32_bf16 v[152:155], v[164:167], v[12:15], v[152:155]
    v_mfma_f32_16x16x32_bf16 v[156:159], v[168:171], v[12:15], v[156:159]
    v_mfma_f32_16x16x32_bf16 v[112:115], v[12:15], v[32:35], v[112:115]
    v_mfma_f32_16x16x32_bf16 v[120:123], v[32:35], v[32:35], v[120:123]
    v_mfma_f32_16x16x32_bf16 v[116:119], v[12:15], v[36:39], v[116:119]
    v_mfma_f32_16x16x32_bf16 v[124:127], v[36:39], v[36:39], v[124:127]
    s_waitcnt lgkmcnt(0)
    s_barrier
    v_mfma_f32_16x16x32_bf16 v[64:67], v[172:175], v[40:43], v[64:67]
    ds_read_b128 v[32:35], v20 offset:32768
    ds_read_b128 v[36:39], v20 offset:36864
    v_mfma_f32_16x16x32_bf16 v[68:71], v[176:179], v[40:43], v[68:71]
    ds_read_b64_tr_b16 v[164:165], v24 offset:32768
    ds_read_b64_tr_b16 v[166:167], v24 offset:33280
    v_mfma_f32_16x16x32_bf16 v[72:75], v[172:175], v[44:47], v[72:75]
    ds_read_b64_tr_b16 v[168:169], v25 offset:32768
    ds_read_b64_tr_b16 v[170:171], v25 offset:33280
    v_mfma_f32_16x16x32_bf16 v[76:79], v[176:179], v[44:47], v[76:79]
    v_mfma_f32_16x16x32_bf16 v[152:155], v[172:175], v[12:15], v[152:155]
    v_mfma_f32_16x16x32_bf16 v[156:159], v[176:179], v[12:15], v[156:159]
    v_mfma_f32_16x16x32_bf16 v[112:115], v[12:15], v[40:43], v[112:115]
    v_mfma_f32_16x16x32_bf16 v[120:123], v[40:43], v[40:43], v[120:123]
    v_mfma_f32_16x16x32_bf16 v[116:119], v[12:15], v[44:47], v[116:119]
    v_mfma_f32_16x16x32_bf16 v[124:127], v[44:47], v[44:47], v[124:127]
    s_waitcnt lgkmcnt(0)
    v_mfma_f32_16x16x32_bf16 v[64:67], v[164:167], v[32:35], v[64:67]
    ds_read_b128 v[40:43], v21 offset:32768
    ds_read_b128 v[44:47], v21 offset:36864
    v_mfma_f32_16x16x32_bf16 v[68:71], v[168:171], v[32:35], v[68:71]
    ds_read_b64_tr_b16 v[172:173], v24 offset:36864
    ds_read_b64_tr_b16 v[174:175], v24 offset:37376
    v_mfma_f32_16x16x32_bf16 v[72:75], v[164:167], v[36:39], v[72:75]
    ds_read_b64_tr_b16 v[176:177], v25 offset:36864
    ds_read_b64_tr_b16 v[178:179], v25 offset:37376
    v_mfma_f32_16x16x32_bf16 v[76:79], v[168:171], v[36:39], v[76:79]
    v_mfma_f32_16x16x32_bf16 v[152:155], v[164:167], v[12:15], v[152:155]
    v_mfma_f32_16x16x32_bf16 v[156:159], v[168:171], v[12:15], v[156:159]
    v_mfma_f32_16x16x32_bf16 v[112:115], v[12:15], v[32:35], v[112:115]
    v_mfma_f32_16x16x32_bf16 v[120:123], v[32:35], v[32:35], v[120:123]
    v_mfma_f32_16x16x32_bf16 v[116:119], v[12:15], v[36:39], v[116:119]
    v_mfma_f32_16x16x32_bf16 v[124:127], v[36:39], v[36:39], v[124:127]
    s_waitcnt lgkmcnt(0)
    v_mfma_f32_16x16x32_bf16 v[64:67], v[172:175], v[40:43], v[64:67]
    ds_read_b128 v[32:35], v22 offset:32768
    ds_read_b128 v[36:39], v22 offset:36864
    v_mfma_f32_16x16x32_bf16 v[68:71], v[176:179], v[40:43], v[68:71]
    ds_read_b64_tr_b16 v[164:165], v24 offset:40960
    ds_read_b64_tr_b16 v[166:167], v24 offset:41472
    v_mfma_f32_16x16x32_bf16 v[72:75], v[172:175], v[44:47], v[72:75]
    ds_read_b64_tr_b16 v[168:169], v25 offset:40960
    ds_read_b64_tr_b16 v[170:171], v25 offset:41472
    v_mfma_f32_16x16x32_bf16 v[76:79], v[176:179], v[44:47], v[76:79]
    v_mfma_f32_16x16x32_bf16 v[152:155], v[172:175], v[12:15], v[152:155]
    v_mfma_f32_16x16x32_bf16 v[156:159], v[176:179], v[12:15], v[156:159]
    v_mfma_f32_16x16x32_bf16 v[112:115], v[12:15], v[40:43], v[112:115]
    v_mfma_f32_16x16x32_bf16 v[120:123], v[40:43], v[40:43], v[120:123]
    v_mfma_f32_16x16x32_bf16 v[116:119], v[12:15], v[44:47], v[116:119]
    v_mfma_f32_16x16x32_bf16 v[124:127], v[44:47], v[44:47], v[124:127]
    s_waitcnt lgkmcnt(0)
    v_mfma_f32_16x16x32_bf16 v[64:67], v[164:167], v[32:35], v[64:67]
    ds_read_b128 v[40:43], v23 offset:32768
    ds_read_b128 v[44:47], v23 offset:36864
    v_mfma_f32_16x16x32_bf16 v[68:71], v[168:171], v[32:35], v[68:71]
    ds_read_b64_tr_b16 v[172:173], v24 offset:45056
    ds_read_b64_tr_b16 v[174:175], v24 offset:45568
    v_mfma_f32_16x16x32_bf16 v[72:75], v[164:167], v[36:39], v[72:75]
    ds_read_b64_tr_b16 v[176:177], v25 offset:45056
    ds_read_b64_tr_b16 v[178:179], v25 offset:45568
    v_mfma_f32_16x16x32_bf16 v[76:79], v[168:171], v[36:39], v[76:79]
    v_mfma_f32_16x16x32_bf16 v[152:155], v[164:167], v[12:15], v[152:155]
    v_mfma_f32_16x16x32_bf16 v[156:159], v[168:171], v[12:15], v[156:159]
    v_mfma_f32_16x16x32_bf16 v[112:115], v[12:15], v[32:35], v[112:115]
    v_mfma_f32_16x16x32_bf16 v[120:123], v[32:35], v[32:35], v[120:123]
    v_mfma_f32_16x16x32_bf16 v[116:119], v[12:15], v[36:39], v[116:119]
    v_mfma_f32_16x16x32_bf16 v[124:127], v[36:39], v[36:39], v[124:127]
    s_waitcnt lgkmcnt(0)
    s_barrier
    s_lshl_b32 s60, s52, 3
    v_mov_b32 v4, s60
    buffer_load_dword v150, v4, s[28:31], 0 offen sc1
    v_mfma_f32_16x16x32_bf16 v[64:67], v[172:175], v[40:43], v[64:67]
    ds_read_b128 v[32:35], v20 offset:49152
    ds_read_b128 v[36:39], v20 offset:53248
    v_mfma_f32_16x16x32_bf16 v[68:71], v[176:179], v[40:43], v[68:71]
    ds_read_b64_tr_b16 v[164:165], v24 offset:49152
    ds_read_b64_tr_b16 v[166:167], v24 offset:49664
    v_mfma_f32_16x16x32_bf16 v[72:75], v[172:175], v[44:47], v[72:75]
    ds_read_b64_tr_b16 v[168:169], v25 offset:49152
    ds_read_b64_tr_b16 v[170:171], v25 offset:49664
    v_mfma_f32_16x16x32_bf16 v[76:79], v[176:179], v[44:47], v[76:79]
    v_mfma_f32_16x16x32_bf16 v[152:155], v[172:175], v[12:15], v[152:155]
    v_mfma_f32_16x16x32_bf16 v[156:159], v[176:179], v[12:15], v[156:159]
    v_mfma_f32_16x16x32_bf16 v[112:115], v[12:15], v[40:43], v[112:115]
    v_mfma_f32_16x16x32_bf16 v[120:123], v[40:43], v[40:43], v[120:123]
    v_mfma_f32_16x16x32_bf16 v[116:119], v[12:15], v[44:47], v[116:119]
    v_mfma_f32_16x16x32_bf16 v[124:127], v[44:47], v[44:47], v[124:127]
    s_waitcnt lgkmcnt(0)
    v_mfma_f32_16x16x32_bf16 v[64:67], v[164:167], v[32:35], v[64:67]
    ds_read_b128 v[40:43], v21 offset:49152
    ds_read_b128 v[44:47], v21 offset:53248
    v_mfma_f32_16x16x32_bf16 v[68:71], v[168:171], v[32:35], v[68:71]
    ds_read_b64_tr_b16 v[172:173], v24 offset:53248
    ds_read_b64_tr_b16 v[174:175], v24 offset:53760
    v_mfma_f32_16x16x32_bf16 v[72:75], v[164:167], v[36:39], v[72:75]
    ds_read_b64_tr_b16 v[176:177], v25 offset:53248
    ds_read_b64_tr_b16 v[178:179], v25 offset:53760
    v_mfma_f32_16x16x32_bf16 v[76:79], v[168:171], v[36:39], v[76:79]
    v_mfma_f32_16x16x32_bf16 v[152:155], v[164:167], v[12:15], v[152:155]
    v_mfma_f32_16x16x32_bf16 v[156:159], v[168:171], v[12:15], v[156:159]
    v_mfma_f32_16x16x32_bf16 v[112:115], v[12:15], v[32:35], v[112:115]
    v_mfma_f32_16x16x32_bf16 v[120:123], v[32:35], v[32:35], v[120:123]
    v_mfma_f32_16x16x32_bf16 v[116:119], v[12:15], v[36:39], v[116:119]
    v_mfma_f32_16x16x32_bf16 v[124:127], v[36:39], v[36:39], v[124:127]
    s_waitcnt lgkmcnt(0)
    s_barrier
    v_mfma_f32_16x16x32_bf16 v[64:67], v[172:175], v[40:43], v[64:67]
    ds_read_b128 v[32:35], v22 offset:49152
    ds_read_b128 v[36:39], v22 offset:53248
    v_mfma_f32_16x16x32_bf16 v[68:71], v[176:179], v[40:43], v[68:71]
    ds_read_b64_tr_b16 v[164:165], v24 offset:57344
    ds_read_b64_tr_b16 v[166:167], v24 offset:57856
    v_mfma_f32_16x16x32_bf16 v[72:75], v[172:175], v[44:47], v[72:75]
    ds_read_b64_tr_b16 v[168:169], v25 offset:57344
    ds_read_b64_tr_b16 v[170:171], v25 offset:57856
    v_mfma_f32_16x16x32_bf16 v[76:79], v[176:179], v[44:47], v[76:79]
    v_mfma_f32_16x16x32_bf16 v[152:155], v[172:175], v[12:15], v[152:155]
    v_mfma_f32_16x16x32_bf16 v[156:159], v[176:179], v[12:15], v[156:159]
    v_mfma_f32_16x16x32_bf16 v[112:115], v[12:15], v[40:43], v[112:115]
    v_mfma_f32_16x16x32_bf16 v[120:123], v[40:43], v[40:43], v[120:123]
    v_mfma_f32_16x16x32_bf16 v[116:119], v[12:15], v[44:47], v[116:119]
    v_mfma_f32_16x16x32_bf16 v[124:127], v[44:47], v[44:47], v[124:127]
    s_waitcnt lgkmcnt(0)
    v_mfma_f32_16x16x32_bf16 v[64:67], v[164:167], v[32:35], v[64:67]
    ds_read_b128 v[40:43], v23 offset:49152
    ds_read_b128 v[44:47], v23 offset:53248
    v_mfma_f32_16x16x32_bf16 v[68:71], v[168:171], v[32:35], v[68:71]
    ds_read_b64_tr_b16 v[172:173], v24 offset:61440
    ds_read_b64_tr_b16 v[174:175], v24 offset:61952
    v_mfma_f32_16x16x32_bf16 v[72:75], v[164:167], v[36:39], v[72:75]
    ds_read_b64_tr_b16 v[176:177], v25 offset:61440
    ds_read_b64_tr_b16 v[178:179], v25 offset:61952
    v_mfma_f32_16x16x32_bf16 v[76:79], v[168:171], v[36:39], v[76:79]
    v_mfma_f32_16x16x32_bf16 v[152:155], v[164:167], v[12:15], v[152:155]
    v_mfma_f32_16x16x32_bf16 v[156:159], v[168:171], v[12:15], v[156:159]
    v_mfma_f32_16x16x32_bf16 v[112:115], v[12:15], v[32:35], v[112:115]
    v_mfma_f32_16x16x32_bf16 v[120:123], v[32:35], v[32:35], v[120:123]
    v_mfma_f32_16x16x32_bf16 v[116:119], v[12:15], v[36:39], v[116:119]
    v_mfma_f32_16x16x32_bf16 v[124:127], v[36:39], v[36:39], v[124:127]
    s_waitcnt lgkmcnt(0)
    v_mfma_f32_16x16x32_bf16 v[64:67], v[172:175], v[40:43], v[64:67]
    v_mfma_f32_16x16x32_bf16 v[68:71], v[176:179], v[40:43], v[68:71]
    v_mfma_f32_16x16x32_bf16 v[72:75], v[172:175], v[44:47], v[72:75]
    v_mfma_f32_16x16x32_bf16 v[76:79], v[176:179], v[44:47], v[76:79]
    v_mfma_f32_16x16x32_bf16 v[152:155], v[172:175], v[12:15], v[152:155]
    v_mfma_f32_16x16x32_bf16 v[156:159], v[176:179], v[12:15], v[156:159]
    v_mfma_f32_16x16x32_bf16 v[112:115], v[12:15], v[40:43], v[112:115]
    v_mfma_f32_16x16x32_bf16 v[120:123], v[40:43], v[40:43], v[120:123]
    v_mfma_f32_16x16x32_bf16 v[116:119], v[12:15], v[44:47], v[116:119]
    v_mfma_f32_16x16x32_bf16 v[124:127], v[44:47], v[44:47], v[124:127]
    s_barrier
    s_waitcnt vmcnt(0)
    s_mov_b32 s77, 0
L_cenA:
    v_readfirstlane_b32 s60, v150
    s_nop 3
    s_and_b32 s61, s60, 0x0f0f0f0f
    s_lshr_b32 s62, s60, 4
    s_and_b32 s62, s62, 0x0f0f0f0f
    s_add_u32 s61, s61, s62
    s_mul_i32 s61, s61, 0x01010101
    s_lshr_b32 s61, s61, 24
    s_cmp_ge_u32 s61, 8
    s_cbranch_scc1 L_cenA_done
    s_add_u32 s77, s77, 1
    s_cmp_gt_u32 s77, 32768
    s_cbranch_scc1 L_cenA_done
    s_lshl_b32 s61, s52, 3
    v_mov_b32 v4, s61
    buffer_load_dword v150, v4, s[28:31], 0 offen sc1
    s_waitcnt vmcnt(0)
    s_branch L_cenA
L_cenA_done:
    s_lshl_b32 s61, s83, 2
    s_lshl_b32 s61, 8, s61
    s_cmp_eq_u32 s60, s61
    s_cselect_b32 s59, 1, 0
    v_lshlrev_b32 v4, 6, v0
    s_mov_b64 exec, 63
    buffer_load_dword v3, v4, s[32:35], s76 offen sc1
    s_mov_b64 exec, -1
    v_cndmask_b32 v8, 0, v120, s[64:65]
    v_cndmask_b32 v8, v8, v121, s[66:67]
    v_cndmask_b32 v8, v8, v122, s[68:69]
    v_cndmask_b32 v8, v8, v123, s[70:71]
    v_cndmask_b32 v9, 0, v124, s[64:65]
    v_cndmask_b32 v9, v9, v125, s[66:67]
    v_cndmask_b32 v9, v9, v126, s[68:69]
    v_cndmask_b32 v9, v9, v127, s[70:71]
    v_mfma_f32_16x16x4_f32 v[120:123], v148, v8, 0
    s_nop 0
    v_mfma_f32_16x16x4_f32 v[124:127], v148, v9, 0
    v_mul_f32 v220, 0xbb000000, v112
    s_nop 6
    v_mul_f32 v4, 0x3b000000, v120
    v_fma_f32 v4, -v220, v220, v4
    v_max_f32 v4, 0, v4
    v_add_f32 v4, 0x3727c5ac, v4
    v_rsq_f32 v222, v4
    v_mov_b32 v221, v220
    v_mov_b32 v223, v222
    v_mov_b32 v221, v222
    v_mul_f32 v4, v221, v221
    v_rcp_f32 v223, v221
    v_mul_f32 v4, v4, v221
    v_mul_f32 v222, 0xbdd2d3e8, v4
    v_mul_f32 v221, 0xc0135761, v221
    v_mul_f32 v224, 0xbb000000, v116
    v_mul_f32 v4, 0x3b000000, v124
    v_fma_f32 v4, -v224, v224, v4
    v_max_f32 v4, 0, v4
    v_add_f32 v4, 0x3727c5ac, v4
    v_rsq_f32 v226, v4
    v_mov_b32 v225, v224
    v_mov_b32 v227, v226
    v_mov_b32 v225, v226
    v_mul_f32 v4, v225, v225
    v_rcp_f32 v227, v225
    v_mul_f32 v4, v4, v225
    v_mul_f32 v226, 0xbdd2d3e8, v4
    v_mul_f32 v225, 0xc0135761, v225
    v_pk_fma_f32 v[188:189], v[152:153], v[220:221], v[64:65] op_sel_hi:[1,0,1]
    v_pk_fma_f32 v[190:191], v[154:155], v[220:221], v[66:67] op_sel_hi:[1,0,1]
    v_pk_fma_f32 v[192:193], v[156:157], v[220:221], v[68:69] op_sel_hi:[1,0,1]
    v_pk_fma_f32 v[194:195], v[158:159], v[220:221], v[70:71] op_sel_hi:[1,0,1]
    v_pk_mul_f32 v[204:205], v[188:189], v[188:189]
    v_pk_mul_f32 v[206:207], v[190:191], v[190:191]
    v_pk_mul_f32 v[208:209], v[192:193], v[192:193]
    v_pk_mul_f32 v[210:211], v[194:195], v[194:195]
    v_pk_fma_f32 v[204:205], v[204:205], v[222:223], v[220:221] op_sel:[0,0,1] op_sel_hi:[1,0,1]
    v_pk_fma_f32 v[206:207], v[206:207], v[222:223], v[220:221] op_sel:[0,0,1] op_sel_hi:[1,0,1]
    v_pk_fma_f32 v[208:209], v[208:209], v[222:223], v[220:221] op_sel:[0,0,1] op_sel_hi:[1,0,1]
    v_pk_fma_f32 v[210:211], v[210:211], v[222:223], v[220:221] op_sel:[0,0,1] op_sel_hi:[1,0,1]
    v_pk_mul_f32 v[204:205], v[204:205], v[188:189]
    v_pk_mul_f32 v[206:207], v[206:207], v[190:191]
    v_pk_mul_f32 v[208:209], v[208:209], v[192:193]
    v_pk_mul_f32 v[210:211], v[210:211], v[194:195]
    v_exp_f32 v204, v204
    v_exp_f32 v205, v205
    v_exp_f32 v206, v206
    v_exp_f32 v207, v207
    v_exp_f32 v208, v208
    v_exp_f32 v209, v209
    v_exp_f32 v210, v210
    v_exp_f32 v211, v211
    v_pk_fma_f32 v[204:205], v[204:205], v[222:223], v[222:223] op_sel:[0,1,1] op_sel_hi:[1,1,1]
    v_pk_fma_f32 v[206:207], v[206:207], v[222:223], v[222:223] op_sel:[0,1,1] op_sel_hi:[1,1,1]
    v_pk_fma_f32 v[208:209], v[208:209], v[222:223], v[222:223] op_sel:[0,1,1] op_sel_hi:[1,1,1]
    v_pk_fma_f32 v[210:211], v[210:211], v[222:223], v[222:223] op_sel:[0,1,1] op_sel_hi:[1,1,1]
    v_rcp_f32 v204, v204
    v_rcp_f32 v205, v205
    v_rcp_f32 v206, v206
    v_rcp_f32 v207, v207
    v_rcp_f32 v208, v208
    v_rcp_f32 v209, v209
    v_rcp_f32 v210, v210
    v_rcp_f32 v211, v211
    v_pk_mul_f32 v[188:189], v[188:189], v[204:205]
    v_pk_mul_f32 v[190:191], v[190:191], v[206:207]
    v_pk_mul_f32 v[192:193], v[192:193], v[208:209]
    v_pk_mul_f32 v[194:195], v[194:195], v[210:211]
    v_cvt_pk_bf16_f32 v128, v188, v189
    v_cvt_pk_bf16_f32 v129, v190, v191
    v_cvt_pk_bf16_f32 v130, v192, v193
    v_cvt_pk_bf16_f32 v131, v194, v195
    v_pk_fma_f32 v[188:189], v[152:153], v[224:225], v[72:73] op_sel_hi:[1,0,1]
    v_pk_fma_f32 v[190:191], v[154:155], v[224:225], v[74:75] op_sel_hi:[1,0,1]
    v_pk_fma_f32 v[192:193], v[156:157], v[224:225], v[76:77] op_sel_hi:[1,0,1]
    v_pk_fma_f32 v[194:195], v[158:159], v[224:225], v[78:79] op_sel_hi:[1,0,1]
    v_pk_mul_f32 v[204:205], v[188:189], v[188:189]
    v_pk_mul_f32 v[206:207], v[190:191], v[190:191]
    v_pk_mul_f32 v[208:209], v[192:193], v[192:193]
    v_pk_mul_f32 v[210:211], v[194:195], v[194:195]
    v_pk_fma_f32 v[204:205], v[204:205], v[226:227], v[224:225] op_sel:[0,0,1] op_sel_hi:[1,0,1]
    v_pk_fma_f32 v[206:207], v[206:207], v[226:227], v[224:225] op_sel:[0,0,1] op_sel_hi:[1,0,1]
    v_pk_fma_f32 v[208:209], v[208:209], v[226:227], v[224:225] op_sel:[0,0,1] op_sel_hi:[1,0,1]
    v_pk_fma_f32 v[210:211], v[210:211], v[226:227], v[224:225] op_sel:[0,0,1] op_sel_hi:[1,0,1]
    v_pk_mul_f32 v[204:205], v[204:205], v[188:189]
    v_pk_mul_f32 v[206:207], v[206:207], v[190:191]
    v_pk_mul_f32 v[208:209], v[208:209], v[192:193]
    v_pk_mul_f32 v[210:211], v[210:211], v[194:195]
    v_exp_f32 v204, v204
    v_exp_f32 v205, v205
    v_exp_f32 v206, v206
    v_exp_f32 v207, v207
    v_exp_f32 v208, v208
    v_exp_f32 v209, v209
    v_exp_f32 v210, v210
    v_exp_f32 v211, v211
    v_pk_fma_f32 v[204:205], v[204:205], v[226:227], v[226:227] op_sel:[0,1,1] op_sel_hi:[1,1,1]
    v_pk_fma_f32 v[206:207], v[206:207], v[226:227], v[226:227] op_sel:[0,1,1] op_sel_hi:[1,1,1]
    v_pk_fma_f32 v[208:209], v[208:209], v[226:227], v[226:227] op_sel:[0,1,1] op_sel_hi:[1,1,1]
    v_pk_fma_f32 v[210:211], v[210:211], v[226:227], v[226:227] op_sel:[0,1,1] op_sel_hi:[1,1,1]
    v_rcp_f32 v204, v204
    v_rcp_f32 v205, v205
    v_rcp_f32 v206, v206
    v_rcp_f32 v207, v207
    v_rcp_f32 v208, v208
    v_rcp_f32 v209, v209
    v_rcp_f32 v210, v210
    v_rcp_f32 v211, v211
    v_pk_mul_f32 v[188:189], v[188:189], v[204:205]
    v_pk_mul_f32 v[190:191], v[190:191], v[206:207]
    v_pk_mul_f32 v[192:193], v[192:193], v[208:209]
    v_pk_mul_f32 v[194:195], v[194:195], v[210:211]
    v_cvt_pk_bf16_f32 v132, v188, v189
    v_cvt_pk_bf16_f32 v133, v190, v191
    v_cvt_pk_bf16_f32 v134, v192, v193
    v_cvt_pk_bf16_f32 v135, v194, v195
    s_add_u32 s63, s90, 1048576
    buffer_store_dwordx4 v[128:131], v1, s[32:35], s63 offen offset:0 sc1
    buffer_store_dwordx4 v[132:135], v1, s[32:35], s63 offen offset:1024 sc1
    s_waitcnt vmcnt(0)
    s_cmp_eq_u32 s59, 1
    s_cbranch_scc1 L_pfA2
    buffer_store_dword v19, v18, s[32:35], 0 offen offset:0 sc1
    s_branch L_pdA2
L_pfA2:
    buffer_store_dword v19, v18, s[32:35], 0 offen offset:0
L_pdA2:
    s_barrier
    s_mov_b32 s77, 0
L_poll0:
    buffer_load_dword v2, v16, s[32:35], s76 offen offset:0 sc1
    s_waitcnt vmcnt(0)
    v_cmp_ne_u32 vcc, 1, v2
    s_add_u32 s77, s77, 1
    s_cmp_gt_u32 s77, 32768
    s_cbranch_scc1 L_poll0_done
    s_cbranch_vccnz L_poll0
L_poll0_done:
    s_barrier
    s_lshr_b32 s60, s52, 3
    s_lshl_b32 s60, s60, 3
    s_add_u32 s60, s60, s53
    s_mul_i32 s60, s60, 43
    s_mul_i32 s61, s54, 11
    s_add_u32 s60, s60, s61
    v_lshrrev_b32 v4, 1, v0
    v_add_u32 v4, s60, v4
    v_lshlrev_b32 v4, 10, v4
    v_and_b32 v5, 1, v0
    v_lshl_add_u32 v4, v5, 6, v4
    v_add_u32 v188, 384, v4
    s_add_u32 m0, s88, 0
    s_xor_b32 s84, s75, 0
    buffer_load_dwordx4 v236, s[32:35], s84 offen sc1 lds
    s_add_u32 m0, s88, 4096
    s_xor_b32 s84, s75, 4096
    buffer_load_dwordx4 v236, s[32:35], s84 offen sc1 lds
    s_add_u32 m0, s88, 8192
    s_xor_b32 s84, s75, 8192
    buffer_load_dwordx4 v236, s[32:35], s84 offen sc1 lds
    s_add_u32 m0, s88, 12288
    s_xor_b32 s84, s75, 12288
    buffer_load_dwordx4 v236, s[32:35], s84 offen sc1 lds
    s_add_u32 m0, s88, 16384
    s_xor_b32 s84, s75, 16384
    buffer_load_dwordx4 v236, s[32:35], s84 offen sc1 lds
    s_add_u32 m0, s88, 20480
    s_xor_b32 s84, s75, 20480
    buffer_load_dwordx4 v236, s[32:35], s84 offen sc1 lds
    s_add_u32 m0, s88, 24576
    s_xor_b32 s84, s75, 24576
    buffer_load_dwordx4 v236, s[32:35], s84 offen sc1 lds
    s_add_u32 m0, s88, 28672
    s_xor_b32 s84, s75, 28672
    buffer_load_dwordx4 v236, s[32:35], s84 offen sc1 lds
    s_waitcnt vmcnt(4)
    s_barrier
    s_add_u32 m0, s88, 32768
    s_xor_b32 s84, s75, 32768
    buffer_load_dwordx4 v236, s[32:35], s84 offen sc1 lds
    s_add_u32 m0, s88, 36864
    s_xor_b32 s84, s75, 36864
    buffer_load_dwordx4 v236, s[32:35], s84 offen sc1 lds
    s_add_u32 m0, s88, 40960
    s_xor_b32 s84, s75, 40960
    buffer_load_dwordx4 v236, s[32:35], s84 offen sc1 lds
    s_add_u32 m0, s88, 45056
    s_xor_b32 s84, s75, 45056
    buffer_load_dwordx4 v236, s[32:35], s84 offen sc1 lds
    s_add_u32 m0, s88, 49152
    s_xor_b32 s84, s75, 49152
    buffer_load_dwordx4 v236, s[32:35], s84 offen sc1 lds
    s_add_u32 m0, s88, 53248
    s_xor_b32 s84, s75, 53248
    buffer_load_dwordx4 v236, s[32:35], s84 offen sc1 lds
    s_add_u32 m0, s88, 57344
    s_xor_b32 s84, s75, 57344
    buffer_load_dwordx4 v236, s[32:35], s84 offen sc1 lds
    s_waitcnt vmcnt(10)
    s_add_u32 m0, s88, 61440
    s_xor_b32 s84, s75, 61440
    buffer_load_dwordx4 v236, s[32:35], s84 offen sc1 lds
    s_waitcnt vmcnt(8)
    s_barrier
    s_cmp_eq_u32 s54, 3
    s_cselect_b32 s61, 20, 22
    s_bfm_b64 exec, s61, 0
    buffer_load_dword v3, v188, s[20:23], 0 offen
    s_mov_b64 exec, -1
    s_add_u32 m0, s89, 61440
    s_xor_b32 s78, s36, 2
    s_mul_i32 s78, s78, 88064
    buffer_load_dwordx4 v237, s[16:19], s78 offen lds
    s_add_u32 m0, s89, 62464
    s_nop 0
    buffer_load_dwordx4 v238, s[16:19], s78 offen lds
    s_waitcnt vmcnt(10)
    s_add_u32 m0, s89, 63488
    s_nop 0
    buffer_load_dwordx4 v239, s[16:19], s78 offen lds
    s_waitcnt vmcnt(8)
    s_barrier
    s_add_u32 m0, s89, 73728
    s_xor_b32 s78, s36, 3
    s_mul_i32 s78, s78, 88064
    buffer_load_dwordx4 v237, s[16:19], s78 offen lds
    s_add_u32 m0, s89, 74752
    s_nop 0
    buffer_load_dwordx4 v238, s[16:19], s78 offen lds
    s_waitcnt vmcnt(8)
    s_barrier
    s_add_u32 m0, s89, 75776
    s_nop 0
    buffer_load_dwordx4 v239, s[16:19], s78 offen lds
    s_add_u32 m0, s89, 0
    s_xor_b32 s78, s36, 4
    s_mul_i32 s78, s78, 88064
    buffer_load_dwordx4 v237, s[16:19], s78 offen lds
    s_waitcnt vmcnt(8)
    s_barrier
    s_barrier
    s_add_u32 m0, s89, 1024
    s_nop 0
    buffer_load_dwordx4 v238, s[16:19], s78 offen lds
    s_add_u32 m0, s89, 2048
    s_nop 0
    buffer_load_dwordx4 v239, s[16:19], s78 offen lds
    s_add_u32 m0, s89, 12288
    s_xor_b32 s78, s36, 5
    s_mul_i32 s78, s78, 88064
    buffer_load_dwordx4 v237, s[16:19], s78 offen lds
    s_waitcnt vmcnt(10)
    s_add_u32 m0, s89, 13312
    s_nop 0
    buffer_load_dwordx4 v238, s[16:19], s78 offen lds
    s_waitcnt vmcnt(10)
    s_add_u32 m0, s89, 14336
    s_nop 0
    buffer_load_dwordx4 v239, s[16:19], s78 offen lds
    s_waitcnt vmcnt(10)
    s_add_u32 m0, s89, 24576
    s_xor_b32 s78, s36, 6
    s_mul_i32 s78, s78, 88064
    buffer_load_dwordx4 v237, s[16:19], s78 offen lds
    s_waitcnt vmcnt(10)
    s_add_u32 m0, s89, 25600
    s_nop 0
    buffer_load_dwordx4 v238, s[16:19], s78 offen lds
    s_waitcnt vmcnt(10)
    s_add_u32 m0, s89, 26624
    s_nop 0
    buffer_load_dwordx4 v239, s[16:19], s78 offen lds
    v_bfe_u32 v4, v0, 2, 2
    v_lshrrev_b32 v5, 4, v0
    v_lshl_add_u32 v4, v5, 2, v4
    v_mul_u32_u24 v4, 96, v4
    v_and_b32 v5, 3, v0
    v_lshl_add_u32 v4, v5, 3, v4
    v_add_u32 v4, s89, v4
    s_cmp_eq_u32 s56, 1
    s_cselect_b32 s60, 32, 0
    v_add_u32 v20, s60, v4
    v_add_u32 v23, 61440, v20
    s_cmp_eq_u32 s56, 1
    s_cselect_b32 s60, 64, 32
    v_add_u32 v21, s60, v4
    v_add_u32 v24, 61440, v21
    s_cmp_eq_u32 s56, 1
    s_cselect_b32 s60, 0, 64
    v_add_u32 v22, s60, v4
    v_add_u32 v25, 61440, v22
    s_lshl_b32 s60, s56, 11
    s_xor_b32 s61, s60, 2048
    s_add_u32 s61, s61, 0
    v_add_u32 v27, s61, v1
    s_add_u32 s61, s60, 0
    v_add_u32 v242, s61, v1
    v_lshlrev_b32 v6, 3, v0
    s_add_u32 s61, s88, 152576
    v_add_u32 v245, s61, v6
    s_xor_b32 s61, s88, 1024
    s_add_u32 s61, s61, 152576
    v_add_u32 v246, s61, v6
    s_lshl_b32 s61, s54, 2
    s_add_u32 s62, s61, 156672
    v_mov_b32 v247, s62
    s_xor_b32 s61, s61, 4
    s_add_u32 s62, s61, 156672
    v_mov_b32 v248, s62
    v_mov_b32 v6, 0
    ds_write_b32 v247, v6
    v_and_b32 v4, 15, v0
    v_lshrrev_b32 v5, 4, v0
    v_lshlrev_b32 v4, 3, v4
    v_add_u32 v26, 151552, v4
    s_lshl_b32 s60, s56, 8
    v_add_u32 v243, s60, v26
    s_xor_b32 s60, s60, 256
    v_add_u32 v244, s60, v26
    v_lshl_add_u32 v28, v5, 11, v4
    s_lshl_b32 s61, s54, 7
    v_add_u32 v29, s61, v26
    s_waitcnt vmcnt(0)
    s_barrier
    s_waitcnt vmcnt(0)
    s_barrier
    s_barrier
    s_lshl_b32 s60, s52, 13
    s_lshl_b32 s61, s54, 7
    s_add_u32 s60, s60, s61
    s_add_u32 s63, s60, 65536
    buffer_load_dwordx2 v[112:113], v28, s[32:35], s63 offen offset:0 sc1
    buffer_load_dwordx2 v[114:115], v28, s[32:35], s63 offen offset:512 sc1
    buffer_load_dwordx2 v[116:117], v28, s[32:35], s63 offen offset:1024 sc1
    buffer_load_dwordx2 v[118:119], v28, s[32:35], s63 offen offset:1536 sc1
    s_barrier
    ds_read_b64_tr_b16 v[164:165], v20 offset:36864
    ds_read_b64_tr_b16 v[166:167], v20 offset:38400
    ds_read_b64_tr_b16 v[168:169], v21 offset:36864
    ds_read_b64_tr_b16 v[170:171], v21 offset:38400
    ds_read_b64_tr_b16 v[172:173], v22 offset:36864
    ds_read_b64_tr_b16 v[174:175], v22 offset:38400
    ds_read_b128 v[32:35], v27 offset:0
    ds_read_b128 v[36:39], v27 offset:1024
    ds_read_b128 v[40:43], v242 offset:0
    ds_read_b128 v[44:47], v242 offset:1024
    s_waitcnt lgkmcnt(0)
    s_barrier
    v_mfma_f32_16x16x32_bf16 v[64:67], v[164:167], v[32:35], 0
    ds_read_b64_tr_b16 v[176:177], v20 offset:49152
    ds_read_b64_tr_b16 v[178:179], v20 offset:50688
    v_mfma_f32_16x16x32_bf16 v[68:71], v[168:171], v[32:35], 0
    ds_read_b64_tr_b16 v[180:181], v21 offset:49152
    ds_read_b64_tr_b16 v[182:183], v21 offset:50688
    v_mfma_f32_16x16x32_bf16 v[72:75], v[172:175], v[32:35], 0
    ds_read_b64_tr_b16 v[184:185], v22 offset:49152
    ds_read_b64_tr_b16 v[186:187], v22 offset:50688
    v_mfma_f32_16x16x32_bf16 v[76:79], v[164:167], v[36:39], 0
    ds_read_b128 v[48:51], v27 offset:4096
    ds_read_b128 v[52:55], v27 offset:5120
    v_mfma_f32_16x16x32_bf16 v[80:83], v[168:171], v[36:39], 0
    ds_read_b128 v[56:59], v242 offset:4096
    ds_read_b128 v[60:63], v242 offset:5120
    v_mfma_f32_16x16x32_bf16 v[84:87], v[172:175], v[36:39], 0
    v_mfma_f32_16x16x32_bf16 v[88:91], v[164:167], v[40:43], 0
    v_mfma_f32_16x16x32_bf16 v[92:95], v[168:171], v[40:43], 0
    v_mfma_f32_16x16x32_bf16 v[96:99], v[172:175], v[40:43], 0
    v_mfma_f32_16x16x32_bf16 v[100:103], v[164:167], v[44:47], 0
    v_mfma_f32_16x16x32_bf16 v[104:107], v[168:171], v[44:47], 0
    v_mfma_f32_16x16x32_bf16 v[108:111], v[172:175], v[44:47], 0
    v_mfma_f32_16x16x32_bf16 v[152:155], v[164:167], v[12:15], 0
    v_mfma_f32_16x16x32_bf16 v[156:159], v[168:171], v[12:15], 0
    v_mfma_f32_16x16x32_bf16 v[160:163], v[172:175], v[12:15], 0
    s_waitcnt lgkmcnt(0)
    s_barrier
    v_mfma_f32_16x16x32_bf16 v[64:67], v[176:179], v[48:51], v[64:67]
    ds_read_b64_tr_b16 v[164:165], v23 offset:0
    ds_read_b64_tr_b16 v[166:167], v23 offset:1536
    v_mfma_f32_16x16x32_bf16 v[68:71], v[180:183], v[48:51], v[68:71]
    ds_read_b64_tr_b16 v[168:169], v24 offset:0
    ds_read_b64_tr_b16 v[170:171], v24 offset:1536
    v_mfma_f32_16x16x32_bf16 v[72:75], v[184:187], v[48:51], v[72:75]
    ds_read_b64_tr_b16 v[172:173], v25 offset:0
    ds_read_b64_tr_b16 v[174:175], v25 offset:1536
    v_mfma_f32_16x16x32_bf16 v[76:79], v[176:179], v[52:55], v[76:79]
    ds_read_b128 v[32:35], v27 offset:8192
    ds_read_b128 v[36:39], v27 offset:9216
    v_mfma_f32_16x16x32_bf16 v[80:83], v[180:183], v[52:55], v[80:83]
    ds_read_b128 v[40:43], v242 offset:8192
    ds_read_b128 v[44:47], v242 offset:9216
    v_mfma_f32_16x16x32_bf16 v[84:87], v[184:187], v[52:55], v[84:87]
    v_mfma_f32_16x16x32_bf16 v[88:91], v[176:179], v[56:59], v[88:91]
    v_mfma_f32_16x16x32_bf16 v[92:95], v[180:183], v[56:59], v[92:95]
    v_mfma_f32_16x16x32_bf16 v[96:99], v[184:187], v[56:59], v[96:99]
    v_mfma_f32_16x16x32_bf16 v[100:103], v[176:179], v[60:63], v[100:103]
    v_mfma_f32_16x16x32_bf16 v[104:107], v[180:183], v[60:63], v[104:107]
    v_mfma_f32_16x16x32_bf16 v[108:111], v[184:187], v[60:63], v[108:111]
    v_mfma_f32_16x16x32_bf16 v[152:155], v[176:179], v[12:15], v[152:155]
    v_mfma_f32_16x16x32_bf16 v[156:159], v[180:183], v[12:15], v[156:159]
    v_mfma_f32_16x16x32_bf16 v[160:163], v[184:187], v[12:15], v[160:163]
    s_waitcnt lgkmcnt(0)
    s_barrier
    v_mfma_f32_16x16x32_bf16 v[64:67], v[164:167], v[32:35], v[64:67]
    ds_read_b64_tr_b16 v[176:177], v23 offset:12288
    ds_read_b64_tr_b16 v[178:179], v23 offset:13824
    v_mfma_f32_16x16x32_bf16 v[68:71], v[168:171], v[32:35], v[68:71]
    ds_read_b64_tr_b16 v[180:181], v24 offset:12288
    ds_read_b64_tr_b16 v[182:183], v24 offset:13824
    v_mfma_f32_16x16x32_bf16 v[72:75], v[172:175], v[32:35], v[72:75]
    ds_read_b64_tr_b16 v[184:185], v25 offset:12288
    ds_read_b64_tr_b16 v[186:187], v25 offset:13824
    v_mfma_f32_16x16x32_bf16 v[76:79], v[164:167], v[36:39], v[76:79]
    ds_read_b128 v[48:51], v27 offset:12288
    ds_read_b128 v[52:55], v27 offset:13312
    v_mfma_f32_16x16x32_bf16 v[80:83], v[168:171], v[36:39], v[80:83]
    ds_read_b128 v[56:59], v242 offset:12288
    ds_read_b128 v[60:63], v242 offset:13312
    v_mfma_f32_16x16x32_bf16 v[84:87], v[172:175], v[36:39], v[84:87]
    v_mfma_f32_16x16x32_bf16 v[88:91], v[164:167], v[40:43], v[88:91]
    v_mfma_f32_16x16x32_bf16 v[92:95], v[168:171], v[40:43], v[92:95]
    v_mfma_f32_16x16x32_bf16 v[96:99], v[172:175], v[40:43], v[96:99]
    v_mfma_f32_16x16x32_bf16 v[100:103], v[164:167], v[44:47], v[100:103]
    v_mfma_f32_16x16x32_bf16 v[104:107], v[168:171], v[44:47], v[104:107]
    v_mfma_f32_16x16x32_bf16 v[108:111], v[172:175], v[44:47], v[108:111]
    v_mfma_f32_16x16x32_bf16 v[152:155], v[164:167], v[12:15], v[152:155]
    v_mfma_f32_16x16x32_bf16 v[156:159], v[168:171], v[12:15], v[156:159]
    v_mfma_f32_16x16x32_bf16 v[160:163], v[172:175], v[12:15], v[160:163]
    s_waitcnt lgkmcnt(0)
    s_barrier
    v_mfma_f32_16x16x32_bf16 v[64:67], v[176:179], v[48:51], v[64:67]
    ds_read_b64_tr_b16 v[164:165], v20 offset:0
    ds_read_b64_tr_b16 v[166:167], v20 offset:1536
    v_mfma_f32_16x16x32_bf16 v[68:71], v[180:183], v[48:51], v[68:71]
    ds_read_b64_tr_b16 v[168:169], v21 offset:0
    ds_read_b64_tr_b16 v[170:171], v21 offset:1536
    v_mfma_f32_16x16x32_bf16 v[72:75], v[184:187], v[48:51], v[72:75]
    ds_read_b64_tr_b16 v[172:173], v22 offset:0
    ds_read_b64_tr_b16 v[174:175], v22 offset:1536
    v_mfma_f32_16x16x32_bf16 v[76:79], v[176:179], v[52:55], v[76:79]
    ds_read_b128 v[32:35], v27 offset:16384
    ds_read_b128 v[36:39], v27 offset:17408
    v_mfma_f32_16x16x32_bf16 v[80:83], v[180:183], v[52:55], v[80:83]
    ds_read_b128 v[40:43], v242 offset:16384
    ds_read_b128 v[44:47], v242 offset:17408
    v_mfma_f32_16x16x32_bf16 v[84:87], v[184:187], v[52:55], v[84:87]
    v_mfma_f32_16x16x32_bf16 v[88:91], v[176:179], v[56:59], v[88:91]
    v_mfma_f32_16x16x32_bf16 v[92:95], v[180:183], v[56:59], v[92:95]
    v_mfma_f32_16x16x32_bf16 v[96:99], v[184:187], v[56:59], v[96:99]
    v_mfma_f32_16x16x32_bf16 v[100:103], v[176:179], v[60:63], v[100:103]
    v_mfma_f32_16x16x32_bf16 v[104:107], v[180:183], v[60:63], v[104:107]
    v_mfma_f32_16x16x32_bf16 v[108:111], v[184:187], v[60:63], v[108:111]
    v_mfma_f32_16x16x32_bf16 v[152:155], v[176:179], v[12:15], v[152:155]
    v_mfma_f32_16x16x32_bf16 v[156:159], v[180:183], v[12:15], v[156:159]
    v_mfma_f32_16x16x32_bf16 v[160:163], v[184:187], v[12:15], v[160:163]
    s_waitcnt lgkmcnt(0)
    s_barrier
    s_waitcnt vmcnt(0)
    v_pk_add_f32 v[112:113], v[112:113], v[114:115]
    v_pk_add_f32 v[116:117], v[116:117], v[118:119]
    v_pk_add_f32 v[112:113], v[112:113], v[116:117]
    s_nop 1
    v_mfma_f32_16x16x4_f32 v[120:123], v148, v112, 0
    v_mfma_f32_16x16x4_f32 v[124:127], v148, v113, 0
    v_mfma_f32_16x16x32_bf16 v[64:67], v[164:167], v[32:35], v[64:67]
    ds_read_b64_tr_b16 v[176:177], v20 offset:12288
    ds_read_b64_tr_b16 v[178:179], v20 offset:13824
    v_mfma_f32_16x16x32_bf16 v[68:71], v[168:171], v[32:35], v[68:71]
    ds_read_b64_tr_b16 v[180:181], v21 offset:12288
    ds_read_b64_tr_b16 v[182:183], v21 offset:13824
    v_mfma_f32_16x16x32_bf16 v[72:75], v[172:175], v[32:35], v[72:75]
    ds_read_b64_tr_b16 v[184:185], v22 offset:12288
    ds_read_b64_tr_b16 v[186:187], v22 offset:13824
    v_mfma_f32_16x16x32_bf16 v[76:79], v[164:167], v[36:39], v[76:79]
    ds_read_b128 v[48:51], v27 offset:20480
    ds_read_b128 v[52:55], v27 offset:21504
    v_mfma_f32_16x16x32_bf16 v[80:83], v[168:171], v[36:39], v[80:83]
    ds_read_b128 v[56:59], v242 offset:20480
    ds_read_b128 v[60:63], v242 offset:21504
    v_mfma_f32_16x16x32_bf16 v[84:87], v[172:175], v[36:39], v[84:87]
    v_mfma_f32_16x16x32_bf16 v[88:91], v[164:167], v[40:43], v[88:91]
    v_mfma_f32_16x16x32_bf16 v[92:95], v[168:171], v[40:43], v[92:95]
    v_mfma_f32_16x16x32_bf16 v[96:99], v[172:175], v[40:43], v[96:99]
    v_mfma_f32_16x16x32_bf16 v[100:103], v[164:167], v[44:47], v[100:103]
    v_mfma_f32_16x16x32_bf16 v[104:107], v[168:171], v[44:47], v[104:107]
    v_mfma_f32_16x16x32_bf16 v[108:111], v[172:175], v[44:47], v[108:111]
    v_mfma_f32_16x16x32_bf16 v[152:155], v[164:167], v[12:15], v[152:155]
    v_mfma_f32_16x16x32_bf16 v[156:159], v[168:171], v[12:15], v[156:159]
    v_mfma_f32_16x16x32_bf16 v[160:163], v[172:175], v[12:15], v[160:163]
    s_waitcnt lgkmcnt(0)
    s_barrier
    v_mul_f32 v220, 0xbb000000, v120
    v_mul_f32 v4, 0x3b000000, v124
    v_fma_f32 v4, -v220, v220, v4
    v_max_f32 v4, 0, v4
    v_add_f32 v4, 0x3727c5ac, v4
    v_rsq_f32 v222, v4
    v_mov_b32 v221, v220
    v_mov_b32 v223, v222
    v_mov_b32 v221, v222
    ds_write_b64 v29, v[220:221]
    v_mfma_f32_16x16x32_bf16 v[64:67], v[176:179], v[48:51], v[64:67]
    ds_read_b64_tr_b16 v[164:165], v20 offset:24576
    ds_read_b64_tr_b16 v[166:167], v20 offset:26112
    v_mfma_f32_16x16x32_bf16 v[68:71], v[180:183], v[48:51], v[68:71]
    ds_read_b64_tr_b16 v[168:169], v21 offset:24576
    ds_read_b64_tr_b16 v[170:171], v21 offset:26112
    v_mfma_f32_16x16x32_bf16 v[72:75], v[184:187], v[48:51], v[72:75]
    ds_read_b64_tr_b16 v[172:173], v22 offset:24576
    ds_read_b64_tr_b16 v[174:175], v22 offset:26112
    v_mfma_f32_16x16x32_bf16 v[76:79], v[176:179], v[52:55], v[76:79]
    ds_read_b128 v[32:35], v27 offset:24576
    ds_read_b128 v[36:39], v27 offset:25600
    v_mfma_f32_16x16x32_bf16 v[80:83], v[180:183], v[52:55], v[80:83]
    ds_read_b128 v[40:43], v242 offset:24576
    ds_read_b128 v[44:47], v242 offset:25600
    v_mfma_f32_16x16x32_bf16 v[84:87], v[184:187], v[52:55], v[84:87]
    v_mfma_f32_16x16x32_bf16 v[88:91], v[176:179], v[56:59], v[88:91]
    v_mfma_f32_16x16x32_bf16 v[92:95], v[180:183], v[56:59], v[92:95]
    v_mfma_f32_16x16x32_bf16 v[96:99], v[184:187], v[56:59], v[96:99]
    v_mfma_f32_16x16x32_bf16 v[100:103], v[176:179], v[60:63], v[100:103]
    v_mfma_f32_16x16x32_bf16 v[104:107], v[180:183], v[60:63], v[104:107]
    v_mfma_f32_16x16x32_bf16 v[108:111], v[184:187], v[60:63], v[108:111]
    v_mfma_f32_16x16x32_bf16 v[152:155], v[176:179], v[12:15], v[152:155]
    v_mfma_f32_16x16x32_bf16 v[156:159], v[180:183], v[12:15], v[156:159]
    v_mfma_f32_16x16x32_bf16 v[160:163], v[184:187], v[12:15], v[160:163]
    s_waitcnt lgkmcnt(0)
    s_barrier
    v_mfma_f32_16x16x32_bf16 v[64:67], v[164:167], v[32:35], v[64:67]
    ds_read_b64_tr_b16 v[176:177], v20 offset:36864
    ds_read_b64_tr_b16 v[178:179], v20 offset:38400
    v_mfma_f32_16x16x32_bf16 v[68:71], v[168:171], v[32:35], v[68:71]
    ds_read_b64_tr_b16 v[180:181], v21 offset:36864
    ds_read_b64_tr_b16 v[182:183], v21 offset:38400
    v_mfma_f32_16x16x32_bf16 v[72:75], v[172:175], v[32:35], v[72:75]
    ds_read_b64_tr_b16 v[184:185], v22 offset:36864
    ds_read_b64_tr_b16 v[186:187], v22 offset:38400
    v_mfma_f32_16x16x32_bf16 v[76:79], v[164:167], v[36:39], v[76:79]
    ds_read_b128 v[48:51], v27 offset:28672
    ds_read_b128 v[52:55], v27 offset:29696
    v_mfma_f32_16x16x32_bf16 v[80:83], v[168:171], v[36:39], v[80:83]
    ds_read_b128 v[56:59], v242 offset:28672
    ds_read_b128 v[60:63], v242 offset:29696
    v_mfma_f32_16x16x32_bf16 v[84:87], v[172:175], v[36:39], v[84:87]
    v_mfma_f32_16x16x32_bf16 v[88:91], v[164:167], v[40:43], v[88:91]
    v_mfma_f32_16x16x32_bf16 v[92:95], v[168:171], v[40:43], v[92:95]
    v_mfma_f32_16x16x32_bf16 v[96:99], v[172:175], v[40:43], v[96:99]
    v_mfma_f32_16x16x32_bf16 v[100:103], v[164:167], v[44:47], v[100:103]
    v_mfma_f32_16x16x32_bf16 v[104:107], v[168:171], v[44:47], v[104:107]
    v_mfma_f32_16x16x32_bf16 v[108:111], v[172:175], v[44:47], v[108:111]
    v_mfma_f32_16x16x32_bf16 v[152:155], v[164:167], v[12:15], v[152:155]
    v_mfma_f32_16x16x32_bf16 v[156:159], v[168:171], v[12:15], v[156:159]
    v_mfma_f32_16x16x32_bf16 v[160:163], v[172:175], v[12:15], v[160:163]
    s_waitcnt lgkmcnt(0)
    s_barrier
    ds_read_b64 v[220:221], v244 offset:0
    ds_read_b64 v[224:225], v244 offset:128
    ds_read_b64 v[228:229], v243 offset:0
    ds_read_b64 v[232:233], v243 offset:128
    v_mfma_f32_16x16x32_bf16 v[64:67], v[176:179], v[48:51], v[64:67]
    ds_read_b64_tr_b16 v[164:165], v20 offset:49152
    ds_read_b64_tr_b16 v[166:167], v20 offset:50688
    v_mfma_f32_16x16x32_bf16 v[68:71], v[180:183], v[48:51], v[68:71]
    ds_read_b64_tr_b16 v[168:169], v21 offset:49152
    ds_read_b64_tr_b16 v[170:171], v21 offset:50688
    v_mfma_f32_16x16x32_bf16 v[72:75], v[184:187], v[48:51], v[72:75]
    ds_read_b64_tr_b16 v[172:173], v22 offset:49152
    ds_read_b64_tr_b16 v[174:175], v22 offset:50688
    v_mfma_f32_16x16x32_bf16 v[76:79], v[176:179], v[52:55], v[76:79]
    ds_read_b128 v[32:35], v27 offset:32768
    ds_read_b128 v[36:39], v27 offset:33792
    v_mfma_f32_16x16x32_bf16 v[80:83], v[180:183], v[52:55], v[80:83]
    ds_read_b128 v[40:43], v242 offset:32768
    ds_read_b128 v[44:47], v242 offset:33792
    v_mfma_f32_16x16x32_bf16 v[84:87], v[184:187], v[52:55], v[84:87]
    v_mfma_f32_16x16x32_bf16 v[88:91], v[176:179], v[56:59], v[88:91]
    v_mfma_f32_16x16x32_bf16 v[92:95], v[180:183], v[56:59], v[92:95]
    v_mfma_f32_16x16x32_bf16 v[96:99], v[184:187], v[56:59], v[96:99]
    v_mfma_f32_16x16x32_bf16 v[100:103], v[176:179], v[60:63], v[100:103]
    v_mfma_f32_16x16x32_bf16 v[104:107], v[180:183], v[60:63], v[104:107]
    v_mfma_f32_16x16x32_bf16 v[108:111], v[184:187], v[60:63], v[108:111]
    v_mfma_f32_16x16x32_bf16 v[152:155], v[176:179], v[12:15], v[152:155]
    v_mfma_f32_16x16x32_bf16 v[156:159], v[180:183], v[12:15], v[156:159]
    v_mfma_f32_16x16x32_bf16 v[160:163], v[184:187], v[12:15], v[160:163]
    s_waitcnt lgkmcnt(0)
    s_barrier
    v_mfma_f32_16x16x32_bf16 v[64:67], v[164:167], v[32:35], v[64:67]
    ds_read_b64_tr_b16 v[176:177], v23 offset:0
    ds_read_b64_tr_b16 v[178:179], v23 offset:1536
    v_mfma_f32_16x16x32_bf16 v[68:71], v[168:171], v[32:35], v[68:71]
    ds_read_b64_tr_b16 v[180:181], v24 offset:0
    ds_read_b64_tr_b16 v[182:183], v24 offset:1536
    v_mfma_f32_16x16x32_bf16 v[72:75], v[172:175], v[32:35], v[72:75]
    ds_read_b64_tr_b16 v[184:185], v25 offset:0
    ds_read_b64_tr_b16 v[186:187], v25 offset:1536
    v_mfma_f32_16x16x32_bf16 v[76:79], v[164:167], v[36:39], v[76:79]
    ds_read_b128 v[48:51], v27 offset:36864
    ds_read_b128 v[52:55], v27 offset:37888
    v_mfma_f32_16x16x32_bf16 v[80:83], v[168:171], v[36:39], v[80:83]
    ds_read_b128 v[56:59], v242 offset:36864
    ds_read_b128 v[60:63], v242 offset:37888
    v_mfma_f32_16x16x32_bf16 v[84:87], v[172:175], v[36:39], v[84:87]
    v_mfma_f32_16x16x32_bf16 v[88:91], v[164:167], v[40:43], v[88:91]
    v_mfma_f32_16x16x32_bf16 v[92:95], v[168:171], v[40:43], v[92:95]
    v_mfma_f32_16x16x32_bf16 v[96:99], v[172:175], v[40:43], v[96:99]
    v_mfma_f32_16x16x32_bf16 v[100:103], v[164:167], v[44:47], v[100:103]
    v_mfma_f32_16x16x32_bf16 v[104:107], v[168:171], v[44:47], v[104:107]
    v_mfma_f32_16x16x32_bf16 v[108:111], v[172:175], v[44:47], v[108:111]
    v_mfma_f32_16x16x32_bf16 v[152:155], v[164:167], v[12:15], v[152:155]
    v_mfma_f32_16x16x32_bf16 v[156:159], v[168:171], v[12:15], v[156:159]
    v_mfma_f32_16x16x32_bf16 v[160:163], v[172:175], v[12:15], v[160:163]
    s_waitcnt lgkmcnt(0)
    s_barrier
    v_mfma_f32_16x16x32_bf16 v[64:67], v[176:179], v[48:51], v[64:67]
    ds_read_b64_tr_b16 v[164:165], v23 offset:12288
    ds_read_b64_tr_b16 v[166:167], v23 offset:13824
    v_mfma_f32_16x16x32_bf16 v[68:71], v[180:183], v[48:51], v[68:71]
    ds_read_b64_tr_b16 v[168:169], v24 offset:12288
    ds_read_b64_tr_b16 v[170:171], v24 offset:13824
    v_mfma_f32_16x16x32_bf16 v[72:75], v[184:187], v[48:51], v[72:75]
    ds_read_b64_tr_b16 v[172:173], v25 offset:12288
    ds_read_b64_tr_b16 v[174:175], v25 offset:13824
    v_mfma_f32_16x16x32_bf16 v[76:79], v[176:179], v[52:55], v[76:79]
    ds_read_b128 v[32:35], v27 offset:40960
    ds_read_b128 v[36:39], v27 offset:41984
    v_mfma_f32_16x16x32_bf16 v[80:83], v[180:183], v[52:55], v[80:83]
    ds_read_b128 v[40:43], v242 offset:40960
    ds_read_b128 v[44:47], v242 offset:41984
    v_mfma_f32_16x16x32_bf16 v[84:87], v[184:187], v[52:55], v[84:87]
    v_mfma_f32_16x16x32_bf16 v[88:91], v[176:179], v[56:59], v[88:91]
    v_mfma_f32_16x16x32_bf16 v[92:95], v[180:183], v[56:59], v[92:95]
    v_mfma_f32_16x16x32_bf16 v[96:99], v[184:187], v[56:59], v[96:99]
    v_mfma_f32_16x16x32_bf16 v[100:103], v[176:179], v[60:63], v[100:103]
    v_mfma_f32_16x16x32_bf16 v[104:107], v[180:183], v[60:63], v[104:107]
    v_mfma_f32_16x16x32_bf16 v[108:111], v[184:187], v[60:63], v[108:111]
    v_mfma_f32_16x16x32_bf16 v[152:155], v[176:179], v[12:15], v[152:155]
    v_mfma_f32_16x16x32_bf16 v[156:159], v[180:183], v[12:15], v[156:159]
    v_mfma_f32_16x16x32_bf16 v[160:163], v[184:187], v[12:15], v[160:163]
    s_waitcnt lgkmcnt(0)
    s_barrier
    v_mfma_f32_16x16x32_bf16 v[64:67], v[164:167], v[32:35], v[64:67]
    ds_read_b64_tr_b16 v[176:177], v20 offset:0
    ds_read_b64_tr_b16 v[178:179], v20 offset:1536
    v_mfma_f32_16x16x32_bf16 v[68:71], v[168:171], v[32:35], v[68:71]
    ds_read_b64_tr_b16 v[180:181], v21 offset:0
    ds_read_b64_tr_b16 v[182:183], v21 offset:1536
    v_mfma_f32_16x16x32_bf16 v[72:75], v[172:175], v[32:35], v[72:75]
    ds_read_b64_tr_b16 v[184:185], v22 offset:0
    ds_read_b64_tr_b16 v[186:187], v22 offset:1536
    v_mfma_f32_16x16x32_bf16 v[76:79], v[164:167], v[36:39], v[76:79]
    ds_read_b128 v[48:51], v27 offset:45056
    ds_read_b128 v[52:55], v27 offset:46080
    v_mfma_f32_16x16x32_bf16 v[80:83], v[168:171], v[36:39], v[80:83]
    ds_read_b128 v[56:59], v242 offset:45056
    ds_read_b128 v[60:63], v242 offset:46080
    v_mfma_f32_16x16x32_bf16 v[84:87], v[172:175], v[36:39], v[84:87]
    v_mfma_f32_16x16x32_bf16 v[88:91], v[164:167], v[40:43], v[88:91]
    v_mfma_f32_16x16x32_bf16 v[92:95], v[168:171], v[40:43], v[92:95]
    v_mfma_f32_16x16x32_bf16 v[96:99], v[172:175], v[40:43], v[96:99]
    v_mfma_f32_16x16x32_bf16 v[100:103], v[164:167], v[44:47], v[100:103]
    v_mfma_f32_16x16x32_bf16 v[104:107], v[168:171], v[44:47], v[104:107]
    v_mfma_f32_16x16x32_bf16 v[108:111], v[172:175], v[44:47], v[108:111]
    v_mfma_f32_16x16x32_bf16 v[152:155], v[164:167], v[12:15], v[152:155]
    v_mfma_f32_16x16x32_bf16 v[156:159], v[168:171], v[12:15], v[156:159]
    v_mfma_f32_16x16x32_bf16 v[160:163], v[172:175], v[12:15], v[160:163]
    s_waitcnt lgkmcnt(0)
    s_barrier
    v_mfma_f32_16x16x32_bf16 v[64:67], v[176:179], v[48:51], v[64:67]
    ds_read_b64_tr_b16 v[164:165], v20 offset:12288
    ds_read_b64_tr_b16 v[166:167], v20 offset:13824
    v_mfma_f32_16x16x32_bf16 v[68:71], v[180:183], v[48:51], v[68:71]
    ds_read_b64_tr_b16 v[168:169], v21 offset:12288
    ds_read_b64_tr_b16 v[170:171], v21 offset:13824
    v_mfma_f32_16x16x32_bf16 v[72:75], v[184:187], v[48:51], v[72:75]
    ds_read_b64_tr_b16 v[172:173], v22 offset:12288
    ds_read_b64_tr_b16 v[174:175], v22 offset:13824
    v_mfma_f32_16x16x32_bf16 v[76:79], v[176:179], v[52:55], v[76:79]
    ds_read_b128 v[32:35], v27 offset:49152
    ds_read_b128 v[36:39], v27 offset:50176
    v_mfma_f32_16x16x32_bf16 v[80:83], v[180:183], v[52:55], v[80:83]
    ds_read_b128 v[40:43], v242 offset:49152
    ds_read_b128 v[44:47], v242 offset:50176
    v_mfma_f32_16x16x32_bf16 v[84:87], v[184:187], v[52:55], v[84:87]
    v_mfma_f32_16x16x32_bf16 v[88:91], v[176:179], v[56:59], v[88:91]
    v_mfma_f32_16x16x32_bf16 v[92:95], v[180:183], v[56:59], v[92:95]
    v_mfma_f32_16x16x32_bf16 v[96:99], v[184:187], v[56:59], v[96:99]
    v_mfma_f32_16x16x32_bf16 v[100:103], v[176:179], v[60:63], v[100:103]
    v_mfma_f32_16x16x32_bf16 v[104:107], v[180:183], v[60:63], v[104:107]
    v_mfma_f32_16x16x32_bf16 v[108:111], v[184:187], v[60:63], v[108:111]
    v_mfma_f32_16x16x32_bf16 v[152:155], v[176:179], v[12:15], v[152:155]
    v_mfma_f32_16x16x32_bf16 v[156:159], v[180:183], v[12:15], v[156:159]
    v_mfma_f32_16x16x32_bf16 v[160:163], v[184:187], v[12:15], v[160:163]
    s_waitcnt lgkmcnt(0)
    s_barrier
    v_mfma_f32_16x16x32_bf16 v[64:67], v[164:167], v[32:35], v[64:67]
    ds_read_b64_tr_b16 v[176:177], v20 offset:24576
    ds_read_b64_tr_b16 v[178:179], v20 offset:26112
    v_mfma_f32_16x16x32_bf16 v[68:71], v[168:171], v[32:35], v[68:71]
    ds_read_b64_tr_b16 v[180:181], v21 offset:24576
    ds_read_b64_tr_b16 v[182:183], v21 offset:26112
    v_mfma_f32_16x16x32_bf16 v[72:75], v[172:175], v[32:35], v[72:75]
    ds_read_b64_tr_b16 v[184:185], v22 offset:24576
    ds_read_b64_tr_b16 v[186:187], v22 offset:26112
    v_mfma_f32_16x16x32_bf16 v[76:79], v[164:167], v[36:39], v[76:79]
    ds_read_b128 v[48:51], v27 offset:53248
    ds_read_b128 v[52:55], v27 offset:54272
    v_mfma_f32_16x16x32_bf16 v[80:83], v[168:171], v[36:39], v[80:83]
    ds_read_b128 v[56:59], v242 offset:53248
    ds_read_b128 v[60:63], v242 offset:54272
    v_mfma_f32_16x16x32_bf16 v[84:87], v[172:175], v[36:39], v[84:87]
    v_mfma_f32_16x16x32_bf16 v[88:91], v[164:167], v[40:43], v[88:91]
    v_mfma_f32_16x16x32_bf16 v[92:95], v[168:171], v[40:43], v[92:95]
    v_mfma_f32_16x16x32_bf16 v[96:99], v[172:175], v[40:43], v[96:99]
    v_mfma_f32_16x16x32_bf16 v[100:103], v[164:167], v[44:47], v[100:103]
    v_mfma_f32_16x16x32_bf16 v[104:107], v[168:171], v[44:47], v[104:107]
    v_mfma_f32_16x16x32_bf16 v[108:111], v[172:175], v[44:47], v[108:111]
    v_mfma_f32_16x16x32_bf16 v[152:155], v[164:167], v[12:15], v[152:155]
    v_mfma_f32_16x16x32_bf16 v[156:159], v[168:171], v[12:15], v[156:159]
    v_mfma_f32_16x16x32_bf16 v[160:163], v[172:175], v[12:15], v[160:163]
    s_waitcnt lgkmcnt(0)
    s_barrier
    v_mfma_f32_16x16x32_bf16 v[64:67], v[176:179], v[48:51], v[64:67]
    ds_read_b64_tr_b16 v[164:165], v20 offset:36864
    ds_read_b64_tr_b16 v[166:167], v20 offset:38400
    v_mfma_f32_16x16x32_bf16 v[68:71], v[180:183], v[48:51], v[68:71]
    ds_read_b64_tr_b16 v[168:169], v21 offset:36864
    ds_read_b64_tr_b16 v[170:171], v21 offset:38400
    v_mfma_f32_16x16x32_bf16 v[72:75], v[184:187], v[48:51], v[72:75]
    ds_read_b64_tr_b16 v[172:173], v22 offset:36864
    ds_read_b64_tr_b16 v[174:175], v22 offset:38400
    v_mfma_f32_16x16x32_bf16 v[76:79], v[176:179], v[52:55], v[76:79]
    ds_read_b128 v[32:35], v27 offset:57344
    ds_read_b128 v[36:39], v27 offset:58368
    v_mfma_f32_16x16x32_bf16 v[80:83], v[180:183], v[52:55], v[80:83]
    ds_read_b128 v[40:43], v242 offset:57344
    ds_read_b128 v[44:47], v242 offset:58368
    v_mfma_f32_16x16x32_bf16 v[84:87], v[184:187], v[52:55], v[84:87]
    v_mfma_f32_16x16x32_bf16 v[88:91], v[176:179], v[56:59], v[88:91]
    v_mfma_f32_16x16x32_bf16 v[92:95], v[180:183], v[56:59], v[92:95]
    v_mfma_f32_16x16x32_bf16 v[96:99], v[184:187], v[56:59], v[96:99]
    v_mfma_f32_16x16x32_bf16 v[100:103], v[176:179], v[60:63], v[100:103]
    v_mfma_f32_16x16x32_bf16 v[104:107], v[180:183], v[60:63], v[104:107]
    v_mfma_f32_16x16x32_bf16 v[108:111], v[184:187], v[60:63], v[108:111]
    v_mfma_f32_16x16x32_bf16 v[152:155], v[176:179], v[12:15], v[152:155]
    v_mfma_f32_16x16x32_bf16 v[156:159], v[180:183], v[12:15], v[156:159]
    v_mfma_f32_16x16x32_bf16 v[160:163], v[184:187], v[12:15], v[160:163]
    s_waitcnt lgkmcnt(0)
    s_barrier
    v_mfma_f32_16x16x32_bf16 v[64:67], v[164:167], v[32:35], v[64:67]
    ds_read_b64_tr_b16 v[176:177], v20 offset:49152
    ds_read_b64_tr_b16 v[178:179], v20 offset:50688
    v_mfma_f32_16x16x32_bf16 v[68:71], v[168:171], v[32:35], v[68:71]
    ds_read_b64_tr_b16 v[180:181], v21 offset:49152
    ds_read_b64_tr_b16 v[182:183], v21 offset:50688
    v_mfma_f32_16x16x32_bf16 v[72:75], v[172:175], v[32:35], v[72:75]
    ds_read_b64_tr_b16 v[184:185], v22 offset:49152
    ds_read_b64_tr_b16 v[186:187], v22 offset:50688
    v_mfma_f32_16x16x32_bf16 v[76:79], v[164:167], v[36:39], v[76:79]
    ds_read_b128 v[48:51], v27 offset:61440
    ds_read_b128 v[52:55], v27 offset:62464
    v_mfma_f32_16x16x32_bf16 v[80:83], v[168:171], v[36:39], v[80:83]
    ds_read_b128 v[56:59], v242 offset:61440
    ds_read_b128 v[60:63], v242 offset:62464
    v_mfma_f32_16x16x32_bf16 v[84:87], v[172:175], v[36:39], v[84:87]
    v_mfma_f32_16x16x32_bf16 v[88:91], v[164:167], v[40:43], v[88:91]
    v_mfma_f32_16x16x32_bf16 v[92:95], v[168:171], v[40:43], v[92:95]
    v_mfma_f32_16x16x32_bf16 v[96:99], v[172:175], v[40:43], v[96:99]
    v_mfma_f32_16x16x32_bf16 v[100:103], v[164:167], v[44:47], v[100:103]
    v_mfma_f32_16x16x32_bf16 v[104:107], v[168:171], v[44:47], v[104:107]
    v_mfma_f32_16x16x32_bf16 v[108:111], v[172:175], v[44:47], v[108:111]
    v_mfma_f32_16x16x32_bf16 v[152:155], v[164:167], v[12:15], v[152:155]
    v_mfma_f32_16x16x32_bf16 v[156:159], v[168:171], v[12:15], v[156:159]
    v_mfma_f32_16x16x32_bf16 v[160:163], v[172:175], v[12:15], v[160:163]
    s_waitcnt lgkmcnt(0)
    v_mfma_f32_16x16x32_bf16 v[64:67], v[176:179], v[48:51], v[64:67]
    v_mfma_f32_16x16x32_bf16 v[68:71], v[180:183], v[48:51], v[68:71]
    v_mfma_f32_16x16x32_bf16 v[72:75], v[184:187], v[48:51], v[72:75]
    v_mfma_f32_16x16x32_bf16 v[76:79], v[176:179], v[52:55], v[76:79]
    v_mfma_f32_16x16x32_bf16 v[80:83], v[180:183], v[52:55], v[80:83]
    v_mfma_f32_16x16x32_bf16 v[84:87], v[184:187], v[52:55], v[84:87]
    v_mfma_f32_16x16x32_bf16 v[88:91], v[176:179], v[56:59], v[88:91]
    v_mfma_f32_16x16x32_bf16 v[92:95], v[180:183], v[56:59], v[92:95]
    v_mfma_f32_16x16x32_bf16 v[96:99], v[184:187], v[56:59], v[96:99]
    v_mfma_f32_16x16x32_bf16 v[100:103], v[176:179], v[60:63], v[100:103]
    v_mfma_f32_16x16x32_bf16 v[104:107], v[180:183], v[60:63], v[104:107]
    v_mfma_f32_16x16x32_bf16 v[108:111], v[184:187], v[60:63], v[108:111]
    v_mfma_f32_16x16x32_bf16 v[152:155], v[176:179], v[12:15], v[152:155]
    v_mfma_f32_16x16x32_bf16 v[156:159], v[180:183], v[12:15], v[156:159]
    v_mfma_f32_16x16x32_bf16 v[160:163], v[184:187], v[12:15], v[160:163]
    s_barrier
    v_mul_f32 v4, v221, v221
    v_rcp_f32 v223, v221
    v_mul_f32 v4, v4, v221
    v_mul_f32 v222, 0xbdd2d3e8, v4
    v_mul_f32 v221, 0xc0135761, v221
    v_mul_f32 v4, v225, v225
    v_rcp_f32 v227, v225
    v_mul_f32 v4, v4, v225
    v_mul_f32 v226, 0xbdd2d3e8, v4
    v_mul_f32 v225, 0xc0135761, v225
    v_mul_f32 v4, v229, v229
    v_rcp_f32 v231, v229
    v_mul_f32 v4, v4, v229
    v_mul_f32 v230, 0xbdd2d3e8, v4
    v_mul_f32 v229, 0xc0135761, v229
    v_mul_f32 v4, v233, v233
    v_rcp_f32 v235, v233
    v_mul_f32 v4, v4, v233
    v_mul_f32 v234, 0xbdd2d3e8, v4
    v_mul_f32 v233, 0xc0135761, v233
    s_lshl_b32 s91, s91, 12
    s_cmp_lt_u32 s91, 65536
    s_cselect_b32 s60, s99, s79
    s_add_u32 s91, s91, s60
    s_lshl_b32 s92, s92, 12
    s_cmp_lt_u32 s92, 65536
    s_cselect_b32 s60, s99, s79
    s_add_u32 s92, s92, s60
    s_cmp_eq_u32 s93, 1
    s_cselect_b32 s60, 0, 2130706432
    v_add_u32 v28, s60, v1
    s_lshl_b32 s60, s56, 11
    s_add_u32 s92, s92, s60
    s_add_u32 s63, s91, s60
    s_xor_b32 s60, s60, 2048
    s_add_u32 s91, s91, s60
    s_mov_b32 s78, s63
    s_cmp_eq_u32 s56, 1
    s_cselect_b64 s[86:87], -1, 0
    v_pk_fma_f32 v[188:189], v[152:153], v[220:221], v[64:65] op_sel_hi:[1,0,1]
    v_pk_fma_f32 v[190:191], v[154:155], v[220:221], v[66:67] op_sel_hi:[1,0,1]
    v_pk_fma_f32 v[192:193], v[156:157], v[220:221], v[68:69] op_sel_hi:[1,0,1]
    v_pk_fma_f32 v[194:195], v[158:159], v[220:221], v[70:71] op_sel_hi:[1,0,1]
    v_pk_fma_f32 v[196:197], v[160:161], v[220:221], v[72:73] op_sel_hi:[1,0,1]
    v_pk_fma_f32 v[198:199], v[162:163], v[220:221], v[74:75] op_sel_hi:[1,0,1]
    v_pk_mul_f32 v[204:205], v[188:189], v[188:189]
    v_pk_mul_f32 v[206:207], v[190:191], v[190:191]
    v_pk_mul_f32 v[208:209], v[192:193], v[192:193]
    v_pk_mul_f32 v[210:211], v[194:195], v[194:195]
    v_pk_mul_f32 v[212:213], v[196:197], v[196:197]
    v_pk_mul_f32 v[214:215], v[198:199], v[198:199]
    v_pk_fma_f32 v[204:205], v[204:205], v[222:223], v[220:221] op_sel:[0,0,1] op_sel_hi:[1,0,1]
    v_pk_fma_f32 v[206:207], v[206:207], v[222:223], v[220:221] op_sel:[0,0,1] op_sel_hi:[1,0,1]
    v_pk_fma_f32 v[208:209], v[208:209], v[222:223], v[220:221] op_sel:[0,0,1] op_sel_hi:[1,0,1]
    v_pk_fma_f32 v[210:211], v[210:211], v[222:223], v[220:221] op_sel:[0,0,1] op_sel_hi:[1,0,1]
    v_pk_fma_f32 v[212:213], v[212:213], v[222:223], v[220:221] op_sel:[0,0,1] op_sel_hi:[1,0,1]
    v_pk_fma_f32 v[214:215], v[214:215], v[222:223], v[220:221] op_sel:[0,0,1] op_sel_hi:[1,0,1]
    v_pk_mul_f32 v[204:205], v[204:205], v[188:189]
    v_pk_mul_f32 v[206:207], v[206:207], v[190:191]
    v_pk_mul_f32 v[208:209], v[208:209], v[192:193]
    v_pk_mul_f32 v[210:211], v[210:211], v[194:195]
    v_pk_mul_f32 v[212:213], v[212:213], v[196:197]
    v_pk_mul_f32 v[214:215], v[214:215], v[198:199]
    v_exp_f32 v204, v204
    v_exp_f32 v205, v205
    v_exp_f32 v206, v206
    v_exp_f32 v207, v207
    v_exp_f32 v208, v208
    v_exp_f32 v209, v209
    v_exp_f32 v210, v210
    v_exp_f32 v211, v211
    v_exp_f32 v212, v212
    v_exp_f32 v213, v213
    v_exp_f32 v214, v214
    v_exp_f32 v215, v215
    v_pk_fma_f32 v[204:205], v[204:205], v[222:223], v[222:223] op_sel:[0,1,1] op_sel_hi:[1,1,1]
    v_pk_fma_f32 v[206:207], v[206:207], v[222:223], v[222:223] op_sel:[0,1,1] op_sel_hi:[1,1,1]
    v_pk_fma_f32 v[208:209], v[208:209], v[222:223], v[222:223] op_sel:[0,1,1] op_sel_hi:[1,1,1]
    v_pk_fma_f32 v[210:211], v[210:211], v[222:223], v[222:223] op_sel:[0,1,1] op_sel_hi:[1,1,1]
    v_pk_fma_f32 v[212:213], v[212:213], v[222:223], v[222:223] op_sel:[0,1,1] op_sel_hi:[1,1,1]
    v_pk_fma_f32 v[214:215], v[214:215], v[222:223], v[222:223] op_sel:[0,1,1] op_sel_hi:[1,1,1]
    v_rcp_f32 v204, v204
    v_rcp_f32 v205, v205
    v_rcp_f32 v206, v206
    v_rcp_f32 v207, v207
    v_rcp_f32 v208, v208
    v_rcp_f32 v209, v209
    v_rcp_f32 v210, v210
    v_rcp_f32 v211, v211
    v_rcp_f32 v212, v212
    v_rcp_f32 v213, v213
    v_rcp_f32 v214, v214
    v_rcp_f32 v215, v215
    v_pk_mul_f32 v[188:189], v[188:189], v[204:205]
    v_pk_mul_f32 v[190:191], v[190:191], v[206:207]
    v_pk_mul_f32 v[192:193], v[192:193], v[208:209]
    v_pk_mul_f32 v[194:195], v[194:195], v[210:211]
    v_pk_mul_f32 v[196:197], v[196:197], v[212:213]
    v_pk_mul_f32 v[198:199], v[198:199], v[214:215]
    v_cvt_pk_bf16_f32 v64, v188, v189
    v_cvt_pk_bf16_f32 v65, v190, v191
    v_cvt_pk_bf16_f32 v66, v192, v193
    v_cvt_pk_bf16_f32 v67, v194, v195
    v_cvt_pk_bf16_f32 v68, v196, v197
    v_cvt_pk_bf16_f32 v69, v198, v199
    v_pk_fma_f32 v[188:189], v[152:153], v[224:225], v[76:77] op_sel_hi:[1,0,1]
    v_pk_fma_f32 v[190:191], v[154:155], v[224:225], v[78:79] op_sel_hi:[1,0,1]
    v_pk_fma_f32 v[192:193], v[156:157], v[224:225], v[80:81] op_sel_hi:[1,0,1]
    v_pk_fma_f32 v[194:195], v[158:159], v[224:225], v[82:83] op_sel_hi:[1,0,1]
    v_pk_fma_f32 v[196:197], v[160:161], v[224:225], v[84:85] op_sel_hi:[1,0,1]
    v_pk_fma_f32 v[198:199], v[162:163], v[224:225], v[86:87] op_sel_hi:[1,0,1]
    v_pk_mul_f32 v[204:205], v[188:189], v[188:189]
    v_pk_mul_f32 v[206:207], v[190:191], v[190:191]
    v_pk_mul_f32 v[208:209], v[192:193], v[192:193]
    v_pk_mul_f32 v[210:211], v[194:195], v[194:195]
    v_pk_mul_f32 v[212:213], v[196:197], v[196:197]
    v_pk_mul_f32 v[214:215], v[198:199], v[198:199]
    v_pk_fma_f32 v[204:205], v[204:205], v[226:227], v[224:225] op_sel:[0,0,1] op_sel_hi:[1,0,1]
    v_pk_fma_f32 v[206:207], v[206:207], v[226:227], v[224:225] op_sel:[0,0,1] op_sel_hi:[1,0,1]
    v_pk_fma_f32 v[208:209], v[208:209], v[226:227], v[224:225] op_sel:[0,0,1] op_sel_hi:[1,0,1]
    v_pk_fma_f32 v[210:211], v[210:211], v[226:227], v[224:225] op_sel:[0,0,1] op_sel_hi:[1,0,1]
    v_pk_fma_f32 v[212:213], v[212:213], v[226:227], v[224:225] op_sel:[0,0,1] op_sel_hi:[1,0,1]
    v_pk_fma_f32 v[214:215], v[214:215], v[226:227], v[224:225] op_sel:[0,0,1] op_sel_hi:[1,0,1]
    v_pk_mul_f32 v[204:205], v[204:205], v[188:189]
    v_pk_mul_f32 v[206:207], v[206:207], v[190:191]
    v_pk_mul_f32 v[208:209], v[208:209], v[192:193]
    v_pk_mul_f32 v[210:211], v[210:211], v[194:195]
    v_pk_mul_f32 v[212:213], v[212:213], v[196:197]
    v_pk_mul_f32 v[214:215], v[214:215], v[198:199]
    v_exp_f32 v204, v204
    v_exp_f32 v205, v205
    v_exp_f32 v206, v206
    v_exp_f32 v207, v207
    v_exp_f32 v208, v208
    v_exp_f32 v209, v209
    v_exp_f32 v210, v210
    v_exp_f32 v211, v211
    v_exp_f32 v212, v212
    v_exp_f32 v213, v213
    v_exp_f32 v214, v214
    v_exp_f32 v215, v215
    v_pk_fma_f32 v[204:205], v[204:205], v[226:227], v[226:227] op_sel:[0,1,1] op_sel_hi:[1,1,1]
    v_pk_fma_f32 v[206:207], v[206:207], v[226:227], v[226:227] op_sel:[0,1,1] op_sel_hi:[1,1,1]
    v_pk_fma_f32 v[208:209], v[208:209], v[226:227], v[226:227] op_sel:[0,1,1] op_sel_hi:[1,1,1]
    v_pk_fma_f32 v[210:211], v[210:211], v[226:227], v[226:227] op_sel:[0,1,1] op_sel_hi:[1,1,1]
    v_pk_fma_f32 v[212:213], v[212:213], v[226:227], v[226:227] op_sel:[0,1,1] op_sel_hi:[1,1,1]
    v_pk_fma_f32 v[214:215], v[214:215], v[226:227], v[226:227] op_sel:[0,1,1] op_sel_hi:[1,1,1]
    v_rcp_f32 v204, v204
    v_rcp_f32 v205, v205
    v_rcp_f32 v206, v206
    v_rcp_f32 v207, v207
    v_rcp_f32 v208, v208
    v_rcp_f32 v209, v209
    v_rcp_f32 v210, v210
    v_rcp_f32 v211, v211
    v_rcp_f32 v212, v212
    v_rcp_f32 v213, v213
    v_rcp_f32 v214, v214
    v_rcp_f32 v215, v215
    v_pk_mul_f32 v[188:189], v[188:189], v[204:205]
    v_pk_mul_f32 v[190:191], v[190:191], v[206:207]
    v_pk_mul_f32 v[192:193], v[192:193], v[208:209]
    v_pk_mul_f32 v[194:195], v[194:195], v[210:211]
    v_pk_mul_f32 v[196:197], v[196:197], v[212:213]
    v_pk_mul_f32 v[198:199], v[198:199], v[214:215]
    v_cvt_pk_bf16_f32 v76, v188, v189
    v_cvt_pk_bf16_f32 v77, v190, v191
    v_cvt_pk_bf16_f32 v78, v192, v193
    v_cvt_pk_bf16_f32 v79, v194, v195
    v_cvt_pk_bf16_f32 v80, v196, v197
    v_cvt_pk_bf16_f32 v81, v198, v199
    ds_write_b64 v245, v[68:69] offset:0
    ds_write_b64 v245, v[80:81] offset:512
    s_waitcnt lgkmcnt(0)
    v_mov_b32 v4, 1
    ds_write_b32 v247, v4
    v_pk_fma_f32 v[188:189], v[152:153], v[228:229], v[88:89] op_sel_hi:[1,0,1]
    v_pk_fma_f32 v[190:191], v[154:155], v[228:229], v[90:91] op_sel_hi:[1,0,1]
    v_pk_fma_f32 v[192:193], v[156:157], v[228:229], v[92:93] op_sel_hi:[1,0,1]
    v_pk_fma_f32 v[194:195], v[158:159], v[228:229], v[94:95] op_sel_hi:[1,0,1]
    v_pk_fma_f32 v[196:197], v[160:161], v[228:229], v[96:97] op_sel_hi:[1,0,1]
    v_pk_fma_f32 v[198:199], v[162:163], v[228:229], v[98:99] op_sel_hi:[1,0,1]
    v_pk_mul_f32 v[204:205], v[188:189], v[188:189]
    v_pk_mul_f32 v[206:207], v[190:191], v[190:191]
    v_pk_mul_f32 v[208:209], v[192:193], v[192:193]
    v_pk_mul_f32 v[210:211], v[194:195], v[194:195]
    v_pk_mul_f32 v[212:213], v[196:197], v[196:197]
    v_pk_mul_f32 v[214:215], v[198:199], v[198:199]
    v_pk_fma_f32 v[204:205], v[204:205], v[230:231], v[228:229] op_sel:[0,0,1] op_sel_hi:[1,0,1]
    v_pk_fma_f32 v[206:207], v[206:207], v[230:231], v[228:229] op_sel:[0,0,1] op_sel_hi:[1,0,1]
    v_pk_fma_f32 v[208:209], v[208:209], v[230:231], v[228:229] op_sel:[0,0,1] op_sel_hi:[1,0,1]
    v_pk_fma_f32 v[210:211], v[210:211], v[230:231], v[228:229] op_sel:[0,0,1] op_sel_hi:[1,0,1]
    v_pk_fma_f32 v[212:213], v[212:213], v[230:231], v[228:229] op_sel:[0,0,1] op_sel_hi:[1,0,1]
    v_pk_fma_f32 v[214:215], v[214:215], v[230:231], v[228:229] op_sel:[0,0,1] op_sel_hi:[1,0,1]
    v_pk_mul_f32 v[204:205], v[204:205], v[188:189]
    v_pk_mul_f32 v[206:207], v[206:207], v[190:191]
    v_pk_mul_f32 v[208:209], v[208:209], v[192:193]
    v_pk_mul_f32 v[210:211], v[210:211], v[194:195]
    v_pk_mul_f32 v[212:213], v[212:213], v[196:197]
    v_pk_mul_f32 v[214:215], v[214:215], v[198:199]
    v_exp_f32 v204, v204
    v_exp_f32 v205, v205
    v_exp_f32 v206, v206
    v_exp_f32 v207, v207
    v_exp_f32 v208, v208
    v_exp_f32 v209, v209
    v_exp_f32 v210, v210
    v_exp_f32 v211, v211
    v_exp_f32 v212, v212
    v_exp_f32 v213, v213
    v_exp_f32 v214, v214
    v_exp_f32 v215, v215
    v_pk_fma_f32 v[204:205], v[204:205], v[230:231], v[230:231] op_sel:[0,1,1] op_sel_hi:[1,1,1]
    v_pk_fma_f32 v[206:207], v[206:207], v[230:231], v[230:231] op_sel:[0,1,1] op_sel_hi:[1,1,1]
    v_pk_fma_f32 v[208:209], v[208:209], v[230:231], v[230:231] op_sel:[0,1,1] op_sel_hi:[1,1,1]
    v_pk_fma_f32 v[210:211], v[210:211], v[230:231], v[230:231] op_sel:[0,1,1] op_sel_hi:[1,1,1]
    v_pk_fma_f32 v[212:213], v[212:213], v[230:231], v[230:231] op_sel:[0,1,1] op_sel_hi:[1,1,1]
    v_pk_fma_f32 v[214:215], v[214:215], v[230:231], v[230:231] op_sel:[0,1,1] op_sel_hi:[1,1,1]
    v_rcp_f32 v204, v204
    v_rcp_f32 v205, v205
    v_rcp_f32 v206, v206
    v_rcp_f32 v207, v207
    v_rcp_f32 v208, v208
    v_rcp_f32 v209, v209
    v_rcp_f32 v210, v210
    v_rcp_f32 v211, v211
    v_rcp_f32 v212, v212
    v_rcp_f32 v213, v213
    v_rcp_f32 v214, v214
    v_rcp_f32 v215, v215
    v_pk_mul_f32 v[188:189], v[188:189], v[204:205]
    v_pk_mul_f32 v[190:191], v[190:191], v[206:207]
    v_pk_mul_f32 v[192:193], v[192:193], v[208:209]
    v_pk_mul_f32 v[194:195], v[194:195], v[210:211]
    v_pk_mul_f32 v[196:197], v[196:197], v[212:213]
    v_pk_mul_f32 v[198:199], v[198:199], v[214:215]
    v_cvt_pk_bf16_f32 v88, v188, v189
    v_cvt_pk_bf16_f32 v89, v190, v191
    v_cvt_pk_bf16_f32 v90, v192, v193
    v_cvt_pk_bf16_f32 v91, v194, v195
    v_cvt_pk_bf16_f32 v92, v196, v197
    v_cvt_pk_bf16_f32 v93, v198, v199
    s_mov_b32 s77, 0
L_xs:
    ds_read_b32 v4, v248
    s_waitcnt lgkmcnt(0)
    v_readfirstlane_b32 s60, v4
    s_add_u32 s77, s77, 1
    s_cmp_gt_u32 s77, 32768
    s_cbranch_scc1 L_xs_done
    s_cmp_eq_u32 s60, 1
    s_cbranch_scc0 L_xs
L_xs_done:
    ds_read_b64 v[136:137], v246 offset:0
    ds_read_b64 v[138:139], v246 offset:512
    v_pk_fma_f32 v[188:189], v[152:153], v[232:233], v[100:101] op_sel_hi:[1,0,1]
    v_pk_fma_f32 v[190:191], v[154:155], v[232:233], v[102:103] op_sel_hi:[1,0,1]
    v_pk_fma_f32 v[192:193], v[156:157], v[232:233], v[104:105] op_sel_hi:[1,0,1]
    v_pk_fma_f32 v[194:195], v[158:159], v[232:233], v[106:107] op_sel_hi:[1,0,1]
    v_pk_fma_f32 v[196:197], v[160:161], v[232:233], v[108:109] op_sel_hi:[1,0,1]
    v_pk_fma_f32 v[198:199], v[162:163], v[232:233], v[110:111] op_sel_hi:[1,0,1]
    v_pk_mul_f32 v[204:205], v[188:189], v[188:189]
    v_pk_mul_f32 v[206:207], v[190:191], v[190:191]
    v_pk_mul_f32 v[208:209], v[192:193], v[192:193]
    v_pk_mul_f32 v[210:211], v[194:195], v[194:195]
    v_pk_mul_f32 v[212:213], v[196:197], v[196:197]
    v_pk_mul_f32 v[214:215], v[198:199], v[198:199]
    v_pk_fma_f32 v[204:205], v[204:205], v[234:235], v[232:233] op_sel:[0,0,1] op_sel_hi:[1,0,1]
    v_pk_fma_f32 v[206:207], v[206:207], v[234:235], v[232:233] op_sel:[0,0,1] op_sel_hi:[1,0,1]
    v_pk_fma_f32 v[208:209], v[208:209], v[234:235], v[232:233] op_sel:[0,0,1] op_sel_hi:[1,0,1]
    v_pk_fma_f32 v[210:211], v[210:211], v[234:235], v[232:233] op_sel:[0,0,1] op_sel_hi:[1,0,1]
    v_pk_fma_f32 v[212:213], v[212:213], v[234:235], v[232:233] op_sel:[0,0,1] op_sel_hi:[1,0,1]
    v_pk_fma_f32 v[214:215], v[214:215], v[234:235], v[232:233] op_sel:[0,0,1] op_sel_hi:[1,0,1]
    v_pk_mul_f32 v[204:205], v[204:205], v[188:189]
    v_pk_mul_f32 v[206:207], v[206:207], v[190:191]
    v_pk_mul_f32 v[208:209], v[208:209], v[192:193]
    v_pk_mul_f32 v[210:211], v[210:211], v[194:195]
    v_pk_mul_f32 v[212:213], v[212:213], v[196:197]
    v_pk_mul_f32 v[214:215], v[214:215], v[198:199]
    v_exp_f32 v204, v204
    v_exp_f32 v205, v205
    v_exp_f32 v206, v206
    v_exp_f32 v207, v207
    v_exp_f32 v208, v208
    v_exp_f32 v209, v209
    v_exp_f32 v210, v210
    v_exp_f32 v211, v211
    v_exp_f32 v212, v212
    v_exp_f32 v213, v213
    v_exp_f32 v214, v214
    v_exp_f32 v215, v215
    v_pk_fma_f32 v[204:205], v[204:205], v[234:235], v[234:235] op_sel:[0,1,1] op_sel_hi:[1,1,1]
    v_pk_fma_f32 v[206:207], v[206:207], v[234:235], v[234:235] op_sel:[0,1,1] op_sel_hi:[1,1,1]
    v_pk_fma_f32 v[208:209], v[208:209], v[234:235], v[234:235] op_sel:[0,1,1] op_sel_hi:[1,1,1]
    v_pk_fma_f32 v[210:211], v[210:211], v[234:235], v[234:235] op_sel:[0,1,1] op_sel_hi:[1,1,1]
    v_pk_fma_f32 v[212:213], v[212:213], v[234:235], v[234:235] op_sel:[0,1,1] op_sel_hi:[1,1,1]
    v_pk_fma_f32 v[214:215], v[214:215], v[234:235], v[234:235] op_sel:[0,1,1] op_sel_hi:[1,1,1]
    v_rcp_f32 v204, v204
    v_rcp_f32 v205, v205
    v_rcp_f32 v206, v206
    v_rcp_f32 v207, v207
    v_rcp_f32 v208, v208
    v_rcp_f32 v209, v209
    v_rcp_f32 v210, v210
    v_rcp_f32 v211, v211
    v_rcp_f32 v212, v212
    v_rcp_f32 v213, v213
    v_rcp_f32 v214, v214
    v_rcp_f32 v215, v215
    v_pk_mul_f32 v[188:189], v[188:189], v[204:205]
    v_pk_mul_f32 v[190:191], v[190:191], v[206:207]
    v_pk_mul_f32 v[192:193], v[192:193], v[208:209]
    v_pk_mul_f32 v[194:195], v[194:195], v[210:211]
    v_pk_mul_f32 v[196:197], v[196:197], v[212:213]
    v_pk_mul_f32 v[198:199], v[198:199], v[214:215]
    v_cvt_pk_bf16_f32 v100, v188, v189
    v_cvt_pk_bf16_f32 v101, v190, v191
    v_cvt_pk_bf16_f32 v102, v192, v193
    v_cvt_pk_bf16_f32 v103, v194, v195
    v_cvt_pk_bf16_f32 v104, v196, v197
    v_cvt_pk_bf16_f32 v105, v198, v199
    s_waitcnt lgkmcnt(0)
    v_cndmask_b32 v128, v92, v136, s[86:87]
    v_cndmask_b32 v130, v136, v92, s[86:87]
    v_cndmask_b32 v129, v93, v137, s[86:87]
    v_cndmask_b32 v131, v137, v93, s[86:87]
    v_cndmask_b32 v132, v104, v138, s[86:87]
    v_cndmask_b32 v134, v138, v104, s[86:87]
    v_cndmask_b32 v133, v105, v139, s[86:87]
    v_cndmask_b32 v135, v139, v105, s[86:87]
    buffer_store_dwordx4 v[64:67], v1, s[32:35], s91 offen offset:0 sc1
    buffer_store_dwordx4 v[76:79], v1, s[32:35], s91 offen offset:1024 sc1
    buffer_store_dwordx4 v[88:91], v1, s[32:35], s78 offen offset:0 sc1
    buffer_store_dwordx4 v[100:103], v1, s[32:35], s78 offen offset:1024 sc1
    buffer_store_dwordx4 v[128:131], v28, s[32:35], s92 offen offset:0 sc1
    buffer_store_dwordx4 v[132:135], v28, s[32:35], s92 offen offset:1024 sc1
    s_lshl_b32 s94, s55, 15
    s_add_u32 s94, s94, 0
    s_mul_i32 s95, s55, 49152
    s_add_u32 s95, s95, 65536
    s_lshl_b32 s61, s56, 11
    s_add_u32 s94, s94, s61
    s_add_u32 s95, s95, s61
    s_waitcnt vmcnt(0)
    s_cmp_eq_u32 s59, 1
    s_cbranch_scc1 L_pfA4
    buffer_store_dword v19, v18, s[32:35], 0 offen offset:256 sc1
    s_branch L_pdA4
L_pfA4:
    buffer_store_dword v19, v18, s[32:35], 0 offen offset:256
L_pdA4:
    s_mov_b32 s77, 0
L_poll2:
    buffer_load_dword v2, v16, s[32:35], s76 offen offset:256 sc1
    s_waitcnt vmcnt(0)
    v_cmp_ne_u32 vcc, 1, v2
    s_add_u32 s77, s77, 1
    s_cmp_gt_u32 s77, 32768
    s_cbranch_scc1 L_poll2_done
    s_cbranch_vccnz L_poll2
L_poll2_done:
    s_barrier
    s_add_u32 m0, s94, 0
    s_add_u32 s78, s0, 0
    s_cmp_ge_u32 s78, s1
    s_cselect_b32 s2, s1, 0
    s_sub_u32 s78, s78, s2
    s_lshl_b32 s78, s78, 12
    s_add_u32 s78, s78, s82
    s_cmp_lt_u32 s78, 65536
    s_cselect_b32 s2, s99, s79
    s_add_u32 s78, s78, s2
    buffer_load_dwordx4 v241, s[32:35], s78 offen offset:0 sc1 lds
    buffer_load_dwordx4 v241, s[32:35], s78 offen offset:1024 sc1 lds
    s_add_u32 m0, s94, 4096
    s_add_u32 s78, s0, 1
    s_cmp_ge_u32 s78, s1
    s_cselect_b32 s2, s1, 0
    s_sub_u32 s78, s78, s2
    s_lshl_b32 s78, s78, 12
    s_add_u32 s78, s78, s82
    s_cmp_lt_u32 s78, 65536
    s_cselect_b32 s2, s99, s79
    s_add_u32 s78, s78, s2
    buffer_load_dwordx4 v241, s[32:35], s78 offen offset:0 sc1 lds
    buffer_load_dwordx4 v241, s[32:35], s78 offen offset:1024 sc1 lds
    s_add_u32 m0, s94, 8192
    s_add_u32 s78, s0, 2
    s_cmp_ge_u32 s78, s1
    s_cselect_b32 s2, s1, 0
    s_sub_u32 s78, s78, s2
    s_lshl_b32 s78, s78, 12
    s_add_u32 s78, s78, s82
    s_cmp_lt_u32 s78, 65536
    s_cselect_b32 s2, s99, s79
    s_add_u32 s78, s78, s2
    buffer_load_dwordx4 v241, s[32:35], s78 offen offset:0 sc1 lds
    buffer_load_dwordx4 v241, s[32:35], s78 offen offset:1024 sc1 lds
    s_add_u32 m0, s94, 12288
    s_add_u32 s78, s0, 3
    s_cmp_ge_u32 s78, s1
    s_cselect_b32 s2, s1, 0
    s_sub_u32 s78, s78, s2
    s_lshl_b32 s78, s78, 12
    s_add_u32 s78, s78, s82
    s_cmp_lt_u32 s78, 65536
    s_cselect_b32 s2, s99, s79
    s_add_u32 s78, s78, s2
    buffer_load_dwordx4 v241, s[32:35], s78 offen offset:0 sc1 lds
    buffer_load_dwordx4 v241, s[32:35], s78 offen offset:1024 sc1 lds
    s_add_u32 m0, s94, 16384
    s_add_u32 s78, s0, 4
    s_cmp_ge_u32 s78, s1
    s_cselect_b32 s2, s1, 0
    s_sub_u32 s78, s78, s2
    s_lshl_b32 s78, s78, 12
    s_add_u32 s78, s78, s82
    s_cmp_lt_u32 s78, 65536
    s_cselect_b32 s2, s99, s79
    s_add_u32 s78, s78, s2
    buffer_load_dwordx4 v241, s[32:35], s78 offen offset:0 sc1 lds
    buffer_load_dwordx4 v241, s[32:35], s78 offen offset:1024 sc1 lds
    s_waitcnt vmcnt(6)
    s_barrier
    s_add_u32 m0, s94, 20480
    s_add_u32 s78, s0, 5
    s_cmp_ge_u32 s78, s1
    s_cselect_b32 s2, s1, 0
    s_sub_u32 s78, s78, s2
    s_lshl_b32 s78, s78, 12
    s_add_u32 s78, s78, s82
    s_cmp_lt_u32 s78, 65536
    s_cselect_b32 s2, s99, s79
    s_add_u32 s78, s78, s2
    buffer_load_dwordx4 v241, s[32:35], s78 offen offset:0 sc1 lds
    buffer_load_dwordx4 v241, s[32:35], s78 offen offset:1024 sc1 lds
    s_add_u32 m0, s94, 24576
    s_add_u32 s78, s0, 6
    s_cmp_ge_u32 s78, s1
    s_cselect_b32 s2, s1, 0
    s_sub_u32 s78, s78, s2
    s_lshl_b32 s78, s78, 12
    s_add_u32 s78, s78, s82
    s_cmp_lt_u32 s78, 65536
    s_cselect_b32 s2, s99, s79
    s_add_u32 s78, s78, s2
    buffer_load_dwordx4 v241, s[32:35], s78 offen offset:0 sc1 lds
    buffer_load_dwordx4 v241, s[32:35], s78 offen offset:1024 sc1 lds
    s_add_u32 m0, s94, 28672
    s_add_u32 s78, s0, 7
    s_cmp_ge_u32 s78, s1
    s_cselect_b32 s2, s1, 0
    s_sub_u32 s78, s78, s2
    s_lshl_b32 s78, s78, 12
    s_add_u32 s78, s78, s82
    s_cmp_lt_u32 s78, 65536
    s_cselect_b32 s2, s99, s79
    s_add_u32 s78, s78, s2
    buffer_load_dwordx4 v241, s[32:35], s78 offen offset:0 sc1 lds
    s_waitcnt vmcnt(10)
    buffer_load_dwordx4 v241, s[32:35], s78 offen offset:1024 sc1 lds
    s_waitcnt vmcnt(10)
    s_add_u32 m0, s95, 0
    s_add_u32 s78, s0, 8
    s_cmp_ge_u32 s78, s1
    s_cselect_b32 s2, s1, 0
    s_sub_u32 s78, s78, s2
    s_lshl_b32 s78, s78, 12
    s_add_u32 s78, s78, s82
    s_cmp_lt_u32 s78, 65536
    s_cselect_b32 s2, s99, s79
    s_add_u32 s78, s78, s2
    buffer_load_dwordx4 v241, s[32:35], s78 offen offset:0 sc1 lds
    s_waitcnt vmcnt(10)
    buffer_load_dwordx4 v241, s[32:35], s78 offen offset:1024 sc1 lds
    s_waitcnt vmcnt(10)
    s_add_u32 m0, s95, 4096
    s_add_u32 s78, s0, 9
    s_cmp_ge_u32 s78, s1
    s_cselect_b32 s2, s1, 0
    s_sub_u32 s78, s78, s2
    s_lshl_b32 s78, s78, 12
    s_add_u32 s78, s78, s82
    s_cmp_lt_u32 s78, 65536
    s_cselect_b32 s2, s99, s79
    s_add_u32 s78, s78, s2
    buffer_load_dwordx4 v241, s[32:35], s78 offen offset:0 sc1 lds
    s_barrier
    s_waitcnt vmcnt(10)
    buffer_load_dwordx4 v241, s[32:35], s78 offen offset:1024 sc1 lds
    s_waitcnt vmcnt(10)
    s_add_u32 m0, s95, 8192
    s_add_u32 s78, s0, 10
    s_cmp_ge_u32 s78, s1
    s_cselect_b32 s2, s1, 0
    s_sub_u32 s78, s78, s2
    s_lshl_b32 s78, s78, 12
    s_add_u32 s78, s78, s82
    s_cmp_lt_u32 s78, 65536
    s_cselect_b32 s2, s99, s79
    s_add_u32 s78, s78, s2
    buffer_load_dwordx4 v241, s[32:35], s78 offen offset:0 sc1 lds
    s_waitcnt vmcnt(10)
    buffer_load_dwordx4 v241, s[32:35], s78 offen offset:1024 sc1 lds
    s_waitcnt vmcnt(10)
    s_add_u32 m0, s95, 12288
    s_add_u32 s78, s0, 11
    s_cmp_ge_u32 s78, s1
    s_cselect_b32 s2, s1, 0
    s_sub_u32 s78, s78, s2
    s_lshl_b32 s78, s78, 12
    s_add_u32 s78, s78, s82
    s_cmp_lt_u32 s78, 65536
    s_cselect_b32 s2, s99, s79
    s_add_u32 s78, s78, s2
    buffer_load_dwordx4 v241, s[32:35], s78 offen offset:0 sc1 lds
    s_waitcnt vmcnt(10)
    buffer_load_dwordx4 v241, s[32:35], s78 offen offset:1024 sc1 lds
    s_waitcnt vmcnt(10)
    s_add_u32 m0, s95, 16384
    s_add_u32 s78, s0, 12
    s_cmp_ge_u32 s78, s1
    s_cselect_b32 s2, s1, 0
    s_sub_u32 s78, s78, s2
    s_lshl_b32 s78, s78, 12
    s_add_u32 s78, s78, s82
    s_cmp_lt_u32 s78, 65536
    s_cselect_b32 s2, s99, s79
    s_add_u32 s78, s78, s2
    buffer_load_dwordx4 v241, s[32:35], s78 offen offset:0 sc1 lds
    s_waitcnt vmcnt(10)
    buffer_load_dwordx4 v241, s[32:35], s78 offen offset:1024 sc1 lds
    s_waitcnt vmcnt(10)
    s_add_u32 m0, s95, 20480
    s_add_u32 s78, s0, 13
    s_cmp_ge_u32 s78, s1
    s_cselect_b32 s2, s1, 0
    s_sub_u32 s78, s78, s2
    s_lshl_b32 s78, s78, 12
    s_add_u32 s78, s78, s82
    s_cmp_lt_u32 s78, 65536
    s_cselect_b32 s2, s99, s79
    s_add_u32 s78, s78, s2
    buffer_load_dwordx4 v241, s[32:35], s78 offen offset:0 sc1 lds
    s_barrier
    s_waitcnt vmcnt(10)
    buffer_load_dwordx4 v241, s[32:35], s78 offen offset:1024 sc1 lds
    s_waitcnt vmcnt(10)
    s_add_u32 m0, s95, 24576
    s_add_u32 s78, s0, 14
    s_cmp_ge_u32 s78, s1
    s_cselect_b32 s2, s1, 0
    s_sub_u32 s78, s78, s2
    s_lshl_b32 s78, s78, 12
    s_add_u32 s78, s78, s82
    s_cmp_lt_u32 s78, 65536
    s_cselect_b32 s2, s99, s79
    s_add_u32 s78, s78, s2
    buffer_load_dwordx4 v241, s[32:35], s78 offen offset:0 sc1 lds
    s_waitcnt vmcnt(10)
    buffer_load_dwordx4 v241, s[32:35], s78 offen offset:1024 sc1 lds
    s_waitcnt vmcnt(10)
    s_add_u32 m0, s95, 28672
    s_add_u32 s78, s0, 15
    s_cmp_ge_u32 s78, s1
    s_cselect_b32 s2, s1, 0
    s_sub_u32 s78, s78, s2
    s_lshl_b32 s78, s78, 12
    s_add_u32 s78, s78, s82
    s_cmp_lt_u32 s78, 65536
    s_cselect_b32 s2, s99, s79
    s_add_u32 s78, s78, s2
    buffer_load_dwordx4 v241, s[32:35], s78 offen offset:0 sc1 lds
    s_waitcnt vmcnt(10)
    buffer_load_dwordx4 v241, s[32:35], s78 offen offset:1024 sc1 lds
    s_waitcnt vmcnt(10)
    s_add_u32 m0, s95, 32768
    s_add_u32 s78, s0, 16
    s_cmp_ge_u32 s78, s1
    s_cselect_b32 s2, s1, 0
    s_sub_u32 s78, s78, s2
    s_lshl_b32 s78, s78, 12
    s_add_u32 s78, s78, s82
    s_cmp_lt_u32 s78, 65536
    s_cselect_b32 s2, s99, s79
    s_add_u32 s78, s78, s2
    buffer_load_dwordx4 v241, s[32:35], s78 offen offset:0 sc1 lds
    s_waitcnt vmcnt(10)
    buffer_load_dwordx4 v241, s[32:35], s78 offen offset:1024 sc1 lds
    s_waitcnt vmcnt(10)
    s_add_u32 m0, s95, 36864
    s_add_u32 s78, s0, 17
    s_cmp_ge_u32 s78, s1
    s_cselect_b32 s2, s1, 0
    s_sub_u32 s78, s78, s2
    s_lshl_b32 s78, s78, 12
    s_add_u32 s78, s78, s82
    s_cmp_lt_u32 s78, 65536
    s_cselect_b32 s2, s99, s79
    s_add_u32 s78, s78, s2
    buffer_load_dwordx4 v241, s[32:35], s78 offen offset:0 sc1 lds
    s_barrier
    s_waitcnt vmcnt(10)
    buffer_load_dwordx4 v241, s[32:35], s78 offen offset:1024 sc1 lds
    s_waitcnt vmcnt(10)
    s_add_u32 m0, s95, 40960
    s_add_u32 s78, s0, 18
    s_cmp_ge_u32 s78, s1
    s_cselect_b32 s2, s1, 0
    s_sub_u32 s78, s78, s2
    s_lshl_b32 s78, s78, 12
    s_add_u32 s78, s78, s82
    s_cmp_lt_u32 s78, 65536
    s_cselect_b32 s2, s99, s79
    s_add_u32 s78, s78, s2
    buffer_load_dwordx4 v241, s[32:35], s78 offen offset:0 sc1 lds
    s_waitcnt vmcnt(10)
    buffer_load_dwordx4 v241, s[32:35], s78 offen offset:1024 sc1 lds
    s_waitcnt vmcnt(10)
    s_add_u32 m0, s95, 45056
    s_add_u32 s78, s0, 19
    s_cmp_ge_u32 s78, s1
    s_cselect_b32 s2, s1, 0
    s_sub_u32 s78, s78, s2
    s_lshl_b32 s78, s78, 12
    s_add_u32 s78, s78, s82
    s_cmp_lt_u32 s78, 65536
    s_cselect_b32 s2, s99, s79
    s_add_u32 s78, s78, s2
    buffer_load_dwordx4 v241, s[32:35], s78 offen offset:0 sc1 lds
    s_waitcnt vmcnt(10)
    buffer_load_dwordx4 v241, s[32:35], s78 offen offset:1024 sc1 lds
    s_waitcnt vmcnt(10)
    s_add_u32 m0, s94, 0
    s_add_u32 s78, s0, 20
    s_cmp_ge_u32 s78, s1
    s_cselect_b32 s2, s1, 0
    s_sub_u32 s78, s78, s2
    s_lshl_b32 s78, s78, 12
    s_add_u32 s78, s78, s82
    s_cmp_lt_u32 s78, 65536
    s_cselect_b32 s2, s99, s79
    s_add_u32 s78, s78, s2
    buffer_load_dwordx4 v241, s[32:35], s78 offen offset:0 sc1 lds
    s_waitcnt vmcnt(10)
    buffer_load_dwordx4 v241, s[32:35], s78 offen offset:1024 sc1 lds
    s_waitcnt vmcnt(10)
    s_add_u32 m0, s94, 4096
    s_add_u32 s78, s0, 21
    s_cmp_ge_u32 s78, s1
    s_cselect_b32 s2, s1, 0
    s_sub_u32 s78, s78, s2
    s_lshl_b32 s78, s78, 12
    s_add_u32 s78, s78, s82
    s_cmp_lt_u32 s78, 65536
    s_cselect_b32 s2, s99, s79
    s_add_u32 s78, s78, s2
    s_cmp_eq_u32 s55, 1
    s_cselect_b32 s78, 0x40000000, s78
    buffer_load_dwordx4 v241, s[32:35], s78 offen offset:0 sc1 lds
    s_barrier
    s_waitcnt vmcnt(10)
    buffer_load_dwordx4 v241, s[32:35], s78 offen offset:1024 sc1 lds
    s_waitcnt vmcnt(4)
    s_barrier
    s_waitcnt vmcnt(0)
    s_barrier
    s_barrier
    s_endpgm
L_end:
    s_endpgm
L_code_end:
.section .rodata,"a"
.p2align 6
.amdhsa_kernel standalone__mixer_s_mlp__prompt_kernel
  .amdhsa_next_free_vgpr 256
  .amdhsa_next_free_sgpr 102
  .amdhsa_accum_offset 256
  .amdhsa_group_segment_fixed_size 0
  .amdhsa_kernarg_size 64
  .amdhsa_user_sgpr_count 2
  .amdhsa_user_sgpr_kernarg_segment_ptr 1
  .amdhsa_system_sgpr_workgroup_id_x 1
.end_amdhsa_kernel
```
